```python
import torch

def _softmax(x, axis=-1):
    return torch.softmax(x, dim=axis)
def _gelu(x):
    return torch.nn.functional.gelu(x, approximate="tanh")
def _silu(x):
    return torch.nn.functional.silu(x)
def _sigmoid(x):
    return torch.sigmoid(x)
def _layernorm(x, axis=-1, eps=1e-5):
    m = x.mean(dim=axis, keepdim=True)
    v = x.var(dim=axis, keepdim=True, unbiased=False)
    return (x - m) / torch.sqrt(v + eps)
def _scatter_add(tgt, idx, src, axis=0):
    return tgt.clone().index_add_(axis, idx, src)
def _segment_sum(src, seg, n):
    out = torch.zeros((n,) + src.shape[1:], dtype=src.dtype)
    return out.index_add_(0, seg, src)
def _pad(x, pw):
    flat = tuple(v for pair in reversed(pw) for v in pair)
    return torch.nn.functional.pad(x, flat)

kernel_name = 'gated_mix__sliding_local_dilated__sliding_local_dilated__prompt'

def setup_inputs():

    _w = (lambda a: (lambda t: t.to(torch.bfloat16) if t.is_floating_point() else t)(torch.as_tensor(a)))
    def _A_setup():
        B, S, D = 1, 2048, 512
        return {
            "x": _w((lambda *s: torch.randn(*s, dtype=torch.bfloat16) * 0.05)(B, S, D)),
            "wqkv": _w((lambda *s: torch.randn(*s, dtype=torch.bfloat16) * 0.8)(D, 3 * D)),
            "wo": _w((lambda *s: torch.randn(*s, dtype=torch.bfloat16) * 0.05)(D, D)),
        }
    _A_in = _A_setup()

    def _B_setup():
        B, S, D = 1, 2048, 512
        return {
            "x": _w((lambda *s: torch.randn(*s, dtype=torch.bfloat16) * 0.05)(B, S, D)),
            "wqkv": _w((lambda *s: torch.randn(*s, dtype=torch.bfloat16) * 0.8)(D, 3 * D)),
            "wo": _w((lambda *s: torch.randn(*s, dtype=torch.bfloat16) * 0.05)(D, D)),
        }
    _B_in = _B_setup()

    return {
        "A_x": _A_in["x"],
        "A_wqkv": _A_in["wqkv"],
        "A_wo": _A_in["wo"],
        "B_x": _B_in["x"],
        "B_wqkv": _B_in["wqkv"],
        "B_wo": _B_in["wo"],
        "gate_w": _w((lambda *s: torch.randn(*s, dtype=torch.bfloat16) * 0.05)(512) * 16.0),
    }

def reference(A_x, A_wqkv, A_wo, B_x, B_wqkv, B_wo, gate_w):
    def _A_ref(x, wqkv, wo):
        B, S, D = x.shape
        H = 32; Dh = D // H
        W, dil = 8, 2
        qkv = (lambda x, *d: x.permute(*d))((x @ wqkv).reshape(B, S, 3, H, Dh), 2, 0, 3, 1, 4)
        q, k, v = qkv[0], qkv[1], qkv[2]
        scale = Dh ** -0.5
        pos = torch.arange(S)
        off = torch.arange(W) * dil
        idx = pos[:, None] - off[None, :]
        mask = idx >= 0
        idx_c = torch.where(mask, idx, 0).reshape(-1)
        kg = k[:, :, idx_c, :].reshape(B, H, S, W, Dh)
        vg = v[:, :, idx_c, :].reshape(B, H, S, W, Dh)
        logits = torch.einsum("bhsd,bhswd->bhsw", q, kg) * scale
        logits = torch.where(mask[None, None, :, :], logits, -1e9)
        attn = _softmax(logits, axis=-1)
        o = torch.einsum("bhsw,bhswd->bhsd", attn, vg)
        return (lambda x, *d: x.permute(*d))(o, 0, 2, 1, 3).reshape(B, S, D) @ wo

    def _B_ref(x, wqkv, wo):
        B, S, D = x.shape
        H = 32; Dh = D // H
        W, dil = 8, 2
        qkv = (lambda x, *d: x.permute(*d))((x @ wqkv).reshape(B, S, 3, H, Dh), 2, 0, 3, 1, 4)
        q, k, v = qkv[0], qkv[1], qkv[2]
        scale = Dh ** -0.5
        pos = torch.arange(S)
        off = torch.arange(W) * dil
        idx = pos[:, None] - off[None, :]
        mask = idx >= 0
        idx_c = torch.where(mask, idx, 0).reshape(-1)
        kg = k[:, :, idx_c, :].reshape(B, H, S, W, Dh)
        vg = v[:, :, idx_c, :].reshape(B, H, S, W, Dh)
        logits = torch.einsum("bhsd,bhswd->bhsw", q, kg) * scale
        logits = torch.where(mask[None, None, :, :], logits, -1e9)
        attn = _softmax(logits, axis=-1)
        o = torch.einsum("bhsw,bhswd->bhsd", attn, vg)
        return (lambda x, *d: x.permute(*d))(o, 0, 2, 1, 3).reshape(B, S, D) @ wo

    x = A_x
    g = _sigmoid((x * gate_w).sum(-1, keepdims=True))
    a = _A_ref(x, A_wqkv, A_wo)
    b = _B_ref(x, B_wqkv, B_wo)
    return g * a + (1 - g) * b
```

```asm
; @launch grid=(256,1,1) block=(512,1,1) lds=163840
.amdgcn_target "amdgcn-amd-amdhsa--gfx950"
.text
.globl gated_mix__sliding_local_dilated__sliding_local_dilated__prompt_kernel
.p2align 8
.type gated_mix__sliding_local_dilated__sliding_local_dilated__prompt_kernel,@function
gated_mix__sliding_local_dilated__sliding_local_dilated__prompt_kernel:
    s_cmp_ge_u32 s2, 256
    s_cbranch_scc1 L_end
    s_getpc_b64 s[62:63]
    s_and_b32 s44, s2, 2
    s_mul_i32 s44, s44, 12
    s_add_u32 s44, s44, 8
    s_load_dwordx2 s[8:9], s[0:1], s44
    s_load_dwordx2 s[4:5], s[0:1], 0
    v_lshrrev_b32 v2, 6, v0
    v_lshlrev_b32 v1, 7, v0
    v_readfirstlane_b32 s3, v2
    v_min_u32 v1, 10956, v1
    v_and_b32 v0, 63, v0
    global_load_dword v255, v1, s[62:63]
    s_and_b32 s43, s3, 3
    s_cmp_lt_u32 s3, 4
    s_cbranch_scc1 L_compute
    s_setprio 3
    v_lshrrev_b32 v48, 3, v0
    v_and_b32 v49, 7, v0
    v_and_b32 v14, 16, v0
    v_mul_u32_u24 v13, 3072, v48
    v_lshlrev_b32 v15, 4, v49
    v_lshlrev_b32 v14, 1, v14
    v_xad_u32 v7, v15, v14, v13
    s_and_b32 s44, s2, 4
    s_lshr_b32 s45, s2, 6
    s_add_u32 s44, s44, s45
    s_lshl_b32 s44, s44, 7
    s_mul_i32 s51, s43, 6144
    s_lshl3_add_u32 s67, s51, s44
    s_addk_i32 s51, 17408
    s_lshr_b32 s44, s2, 1
    s_and_b32 s44, s44, 4
    s_add_u32 s60, s2, 1
    s_and_b32 s60, s60, 14
    s_add_u32 s60, s60, s44
    s_and_b32 s60, s60, 7
    s_mov_b32 s10, 1572864
    s_lshl_b32 s11, 2, 16
    s_mul_i32 s47, s60, 196608
    s_add_u32 m0, s51, 0
    s_add_u32 s53, s67, s47
    s_waitcnt lgkmcnt(0)
    buffer_load_dwordx4 v7, s[8:11], s53 offen lds
    buffer_load_dwordx4 v7, s[8:11], s53 offen offset:1024 lds
    buffer_load_dwordx4 v7, s[8:11], s53 offen offset:2048 lds
    v_lshrrev_b32 v11, 4, v0
    v_xor_b32 v12, v49, v11
    v_lshlrev_b32 v13, 11, v48
    v_lshl_add_u32 v6, v12, 4, v13
    v_xor_b32 v2, 64, v6
    s_lshr_b32 s39, s2, 3
    v_add_u32 v3, 0x4000, v6
    v_add_u32 v4, 0x8000, v2
    v_add_u32 v5, 0xc000, v6
    s_and_b32 s44, s2, 1
    s_lshl_b32 s44, s44, 10
    s_and_b32 s45, s39, 6
    s_lshl_b32 s45, s45, 7
    s_add_u32 s38, s44, s45
    s_and_b32 s45, s39, 1
    s_add_u32 s38, s38, s45
    s_lshl_b32 s61, s43, 6
    s_add_u32 s61, s61, s38
    s_lshl_b32 s61, s61, 10
    s_sub_u32 s66, s38, 16
    s_max_i32 s66, s66, 0
    s_lshl_b32 s66, s66, 10
    s_lshl_b32 s50, s43, 12
    s_add_u32 s50, s50, 1024
    s_mov_b32 s6, 2097152
    s_mov_b32 s7, s11
    s_lshl_b32 s46, s60, 7
    s_add_u32 m0, s50, 0
    s_add_u32 s52, s61, s46
    buffer_load_dwordx4 v2, s[4:7], s52 offen lds
    s_add_u32 m0, m0, 1024
    s_add_u32 s68, s66, s46
    buffer_load_dwordx4 v3, s[4:7], s52 offen lds
    s_add_u32 m0, m0, 1024
    s_add_u32 s60, s60, 1
    buffer_load_dwordx4 v4, s[4:7], s52 offen lds
    s_add_u32 m0, m0, 1024
    s_and_b32 s60, s60, 7
    buffer_load_dwordx4 v5, s[4:7], s52 offen lds
    s_cmp_lg_u32 s43, 0
    s_mov_b32 m0, 0
    s_cbranch_scc1 L_nohalo0
    buffer_load_dwordx4 v6, s[4:7], s68 offen lds
L_nohalo0:
    s_add_u32 m0, s51, 3072
    v_xor_b32 v8, 64, v7
    v_add_u32 v8, 24576, v8
    buffer_load_dwordx4 v8, s[8:11], s53 offen lds
    buffer_load_dwordx4 v8, s[8:11], s53 offen offset:1024 lds
    buffer_load_dwordx4 v8, s[8:11], s53 offen offset:2048 lds
    v_and_b32 v10, 15, v0
    s_load_dwordx2 s[12:13], s[0:1], 72
    s_load_dwordx2 s[24:25], s[0:1], 56
    s_mov_b32 s14, 16777216
    s_mov_b32 s15, 0x20000
    s_mov_b32 s26, 2097152
    s_mov_b32 s27, s15
    s_load_dwordx2 s[16:17], s[0:1], 16
    s_load_dwordx2 s[20:21], s[0:1], 40
    s_load_dwordx2 s[32:33], s[0:1], 48
    s_load_dwordx2 s[28:29], s[0:1], 64
    s_movk_i32 s34, 1024
    s_mov_b32 s35, s15
    s_mov_b32 s18, 524288
    s_mov_b32 s19, s15
    s_mov_b32 s22, s18
    s_mov_b32 s23, s15
    s_movk_i32 s30, 256
    s_mov_b32 s31, s15
    s_and_b32 s46, s2, 1
    s_lshl_b32 s46, s46, 3
    s_and_b32 s47, s39, 7
    s_add_u32 s36, s46, s47
    s_and_b32 s46, s2, 2
    s_and_b32 s47, s2, 4
    s_lshl2_add_u32 s46, s46, s47
    s_lshr_b32 s47, s39, 3
    s_add_u32 s37, s46, s47
    s_and_b32 s46, s2, 7
    s_lshl_b32 s46, s46, 2
    s_and_b32 s47, s39, 3
    s_add_u32 s46, s46, s47
    s_lshr_b32 s40, s46, 1
    s_and_b32 s41, s46, 1
    s_lshr_b32 s42, s39, 2
    s_lshr_b32 s57, s3, 2
    s_mul_i32 s80, s42, 2
    s_mov_b32 s65, 0
    s_and_b32 s80, s80, 14
    s_mov_b32 s56, 1048576
    s_lshl2_add_u32 s44, s46, s43
    s_lshl_b32 s47, s44, 6
    s_add_u32 s47, s47, 4718592
    s_lshl_b32 s59, s44, 15
    s_lshl_b32 s45, s57, 14
    s_add_u32 s59, s59, s45
    s_lshl_b32 s64, s3, 11
    s_add_u32 s64, s64, 65536
    s_lshl_b32 s72, s80, 10
    s_add_u32 s73, s72, 2048
    s_and_b32 s73, s73, 0x3fff
    s_add_u32 s74, s73, 2048
    s_and_b32 s74, s74, 0x3fff
    s_add_u32 s75, s74, 2048
    s_and_b32 s75, s75, 0x3fff
    s_add_u32 s76, s75, 2048
    s_and_b32 s76, s76, 0x3fff
    s_add_u32 s77, s76, 2048
    s_and_b32 s77, s77, 0x3fff
    s_add_u32 s78, s77, 2048
    s_and_b32 s78, s78, 0x3fff
    s_add_u32 s79, s78, 2048
    s_and_b32 s79, s79, 0x3fff
    v_and_b32 v12, 1, v11
    v_lshrrev_b32 v13, 1, v11
    v_lshlrev_b32 v14, 15, v12
    v_lshl_add_u32 v14, v13, 8, v14
    v_lshl_add_u32 v14, v10, 4, v14
    s_lshl_b32 s44, s36, 18
    s_lshl_b32 s45, s37, 11
    s_add_u32 s44, s44, s45
    s_lshl_b32 s45, s43, 9
    s_add_u32 s44, s44, s45
    v_add_u32 v39, s44, v14
    v_lshlrev_b32 v14, 5, v12
    v_lshl_add_u32 v14, v13, 4, v14
    v_lshl_add_u32 v14, v10, 11, v14
    s_lshr_b32 s44, s40, 1
    s_lshl_b32 s44, s44, 8
    s_and_b32 s45, s40, 1
    s_add_u32 s44, s44, s45
    s_lshl_b32 s45, s41, 7
    s_add_u32 s44, s44, s45
    s_lshl_b32 s45, s43, 5
    s_add_u32 s44, s44, s45
    s_lshl_b32 s44, s44, 10
    s_lshl1_add_u32 s45, s42, s57
    s_lshl_b32 s45, s45, 6
    s_add_u32 s44, s44, s45
    v_xor_b32 v12, s57, v12
    v_lshrrev_b32 v15, 2, v10
    v_lshrrev_b32 v13, 1, v15
    v_lshl_add_u32 v12, v12, 1, v13
    v_lshlrev_b32 v12, 5, v12
    v_lshl_add_u32 v12, v15, 7, v12
    v_lshl_add_u32 v12, v11, 10, v12
    v_and_b32 v13, 3, v0
    v_lshl_add_u32 v12, v13, 3, v12
    s_mul_i32 s45, s57, 98304
    v_add_u32 v36, s45, v12
    v_lshl_add_u32 v38, v0, 2, s47
    v_add_u32 v37, s44, v14
    s_lshl_b32 s44, s36, 4
    s_add_u32 s69, s44, s37
    s_lshl2_add_u32 s69, s69, s43
    s_lshl_b32 s69, s69, 2
    s_add_u32 s69, s69, 4784128
    s_lshl_b32 s44, s43, 13
    s_lshl_b32 s45, s42, 7
    s_add_u32 s44, s44, s45
    v_lshl_add_u32 v13, v48, 10, s44
    v_lshlrev_b32 v15, 4, v49
    v_and_b32 v14, 16, v0
    v_lshlrev_b32 v14, 1, v14
    s_and_b32 s45, s43, 1
    s_lshl_b32 s45, s45, 6
    v_or_b32 v14, s45, v14
    v_xad_u32 v1, v15, v14, v13
    s_lshl_b32 s81, s43, 10
    s_lshl_b32 s44, s37, 3
    s_lshl1_add_u32 s44, s43, s44
    v_lshrrev_b32 v13, 5, v0
    v_add_u32 v15, s44, v13
    s_lshl1_add_u32 s44, s44, s38
    s_lshl_b32 s44, s44, 10
    v_lshlrev_b32 v35, 4, v0
    v_add_u32 v34, s44, v35
    s_lshl_b32 s44, s36, 9
    s_add_u32 s44, s44, 4718592
    v_lshl_add_u32 v32, v15, 2, s44
    v_mov_b32 v13, s36
    v_mov_b32 v14, s40
    v_cmp_eq_u32 vcc, 0, v0
    s_nop 1
    v_cndmask_b32 v13, v14, v13, vcc
    v_lshlrev_b32 v9, 2, v13
    s_lshl_b32 s44, s40, 8
    s_add_u32 s44, s44, 4784128
    v_lshl_add_u32 v45, v0, 2, s44
    s_lshl_b32 s44, s40, 3
    s_lshl2_add_u32 s44, s41, s44
    s_lshl_b32 s44, s44, 15
    s_add_u32 s44, s44, 98800
    v_lshl_add_u32 v47, v0, 9, s44
    v_mov_b64 v[40:41], -1
    v_mov_b64 v[42:43], -1
    s_waitcnt lgkmcnt(0)
    s_mul_i32 s47, s60, 196608
    s_add_u32 m0, s51, 41984
    s_add_u32 s53, s67, s47
    buffer_load_dwordx4 v7, s[8:11], s53 offen lds
    buffer_load_dwordx4 v7, s[8:11], s53 offen offset:1024 lds
    buffer_load_dwordx4 v7, s[8:11], s53 offen offset:2048 lds
    s_add_u32 m0, s51, 45056
    s_nop 0
    buffer_load_dwordx4 v8, s[8:11], s53 offen lds
    buffer_load_dwordx4 v8, s[8:11], s53 offen offset:1024 lds
    buffer_load_dwordx4 v8, s[8:11], s53 offen offset:2048 lds
    s_lshl_b32 s46, s60, 7
    s_add_u32 m0, s50, 41984
    s_add_u32 s52, s61, s46
    buffer_load_dwordx4 v2, s[4:7], s52 offen lds
    s_add_u32 m0, m0, 1024
    s_add_u32 s68, s66, s46
    buffer_load_dwordx4 v3, s[4:7], s52 offen lds
    s_add_u32 m0, m0, 1024
    s_add_u32 s60, s60, 1
    buffer_load_dwordx4 v4, s[4:7], s52 offen lds
    s_add_u32 m0, m0, 1024
    s_and_b32 s60, s60, 7
    buffer_load_dwordx4 v5, s[4:7], s52 offen lds
    s_cmp_lg_u32 s43, 0
    s_mov_b32 m0, 41984
    s_cbranch_scc1 L_nohalo1
    buffer_load_dwordx4 v6, s[4:7], s68 offen lds
L_nohalo1:
    s_sub_u32 s58, s36, s37
    s_or_b32 s58, s58, s43
    s_cselect_b32 s58, 16777216, 0
    s_lshl_b32 s44, s36, 8
    s_add_u32 s44, s44, s58
    s_add_u32 s44, s44, 4784128
    v_lshl_add_u32 v13, v0, 2, s44
    v_mov_b32 v14, 0
    buffer_store_dword v14, v13, s[12:15], 0 offen sc1
    s_waitcnt vmcnt(11)
    s_barrier
    s_mul_i32 s47, s60, 196608
    s_add_u32 m0, s51, 83968
    s_add_u32 s53, s67, s47
    buffer_load_dwordx4 v7, s[8:11], s53 offen lds
    buffer_load_dwordx4 v7, s[8:11], s53 offen offset:1024 lds
    buffer_load_dwordx4 v7, s[8:11], s53 offen offset:2048 lds
    s_add_u32 m0, s51, 87040
    s_nop 0
    buffer_load_dwordx4 v8, s[8:11], s53 offen lds
    buffer_load_dwordx4 v8, s[8:11], s53 offen offset:1024 lds
    buffer_load_dwordx4 v8, s[8:11], s53 offen offset:2048 lds
    s_lshl_b32 s46, s60, 7
    s_add_u32 s52, s61, s46
    s_add_u32 s68, s66, s46
    s_add_u32 s60, s60, 1
    s_and_b32 s60, s60, 7
    s_add_u32 m0, s50, 83968
    s_nop 0
    buffer_load_dwordx4 v2, s[4:7], s52 offen lds
    s_add_u32 m0, s50, 84992
    s_nop 0
    buffer_load_dwordx4 v3, s[4:7], s52 offen lds
    s_waitcnt vmcnt(8)
    s_barrier
    s_add_u32 m0, s50, 86016
    s_nop 0
    buffer_load_dwordx4 v4, s[4:7], s52 offen lds
    s_add_u32 m0, s50, 87040
    s_nop 0
    buffer_load_dwordx4 v5, s[4:7], s52 offen lds
    s_cmp_lg_u32 s43, 0
    s_mov_b32 m0, 83968
    s_cbranch_scc1 L_nohalo2
    buffer_load_dwordx4 v6, s[4:7], s68 offen lds
L_nohalo2:
    s_mul_i32 s47, s60, 196608
    s_add_u32 m0, s51, 0
    s_add_u32 s53, s67, s47
    buffer_load_dwordx4 v7, s[8:11], s53 offen lds
    buffer_load_dwordx4 v7, s[8:11], s53 offen offset:1024 lds
    buffer_load_dwordx4 v7, s[8:11], s53 offen offset:2048 lds
    s_add_u32 m0, s51, 3072
    s_nop 0
    buffer_load_dwordx4 v8, s[8:11], s53 offen lds
    buffer_load_dwordx4 v8, s[8:11], s53 offen offset:1024 lds
    buffer_load_dwordx4 v8, s[8:11], s53 offen offset:2048 lds
    s_lshl_b32 s46, s60, 7
    s_add_u32 m0, s50, 0
    s_add_u32 s52, s61, s46
    buffer_load_dwordx4 v2, s[4:7], s52 offen lds
    s_add_u32 m0, m0, 1024
    s_add_u32 s68, s66, s46
    buffer_load_dwordx4 v3, s[4:7], s52 offen lds
    s_add_u32 m0, m0, 1024
    s_add_u32 s60, s60, 1
    buffer_load_dwordx4 v4, s[4:7], s52 offen lds
    s_add_u32 m0, m0, 1024
    s_and_b32 s60, s60, 7
    buffer_load_dwordx4 v5, s[4:7], s52 offen lds
    s_cmp_lg_u32 s43, 0
    s_mov_b32 m0, 0
    s_cbranch_scc1 L_nohalo3
    buffer_load_dwordx4 v6, s[4:7], s68 offen lds
L_nohalo3:
    s_cmp_ge_u32 s43, 2
    s_cselect_b32 s54, s20, s16
    s_cselect_b32 s55, s21, s17
    s_and_b32 s44, s43, 1
    s_lshl1_add_u32 s44, s39, s44
    s_lshl_b32 s44, s44, 13
    v_lshl_add_u32 v13, v0, 10, s44
    v_add_u32 v13, 384, v13
    s_and_b32 s44, s43, 1
    s_lshl1_add_u32 s44, s2, s44
    s_lshl_b32 s44, s44, 10
    s_sub_u32 s44, s44, 1024
    v_lshl_add_u32 v14, v0, 7, s44
    v_cmp_gt_u32 vcc, 8, v0
    s_nop 1
    v_cndmask_b32 v13, v14, v13, vcc
    s_mov_b64 exec, 0xffff
    global_load_dword v60, v13, s[54:55]
    s_mov_b64 exec, -1
    s_lshl2_add_u32 s44, s36, s58
    v_mov_b32 v13, s44
    v_mov_b32 v14, 1
    s_mov_b64 exec, 1
    buffer_store_dword v14, v13, s[28:31], 0 offen offset:64 sc1
    s_mov_b64 exec, -1
    s_waitcnt vmcnt(12)
    s_barrier
    s_mul_i32 s47, s60, 196608
    s_add_u32 m0, s51, 41984
    s_add_u32 s53, s67, s47
    buffer_load_dwordx4 v7, s[8:11], s53 offen lds
    buffer_load_dwordx4 v7, s[8:11], s53 offen offset:1024 lds
    buffer_load_dwordx4 v7, s[8:11], s53 offen offset:2048 lds
    s_add_u32 m0, s51, 45056
    s_nop 0
    buffer_load_dwordx4 v8, s[8:11], s53 offen lds
    buffer_load_dwordx4 v8, s[8:11], s53 offen offset:1024 lds
    buffer_load_dwordx4 v8, s[8:11], s53 offen offset:2048 lds
    s_lshl_b32 s46, s60, 7
    s_add_u32 m0, s50, 41984
    s_add_u32 s52, s61, s46
    buffer_load_dwordx4 v2, s[4:7], s52 offen lds
    s_add_u32 m0, m0, 1024
    s_add_u32 s68, s66, s46
    buffer_load_dwordx4 v3, s[4:7], s52 offen lds
    s_add_u32 m0, m0, 1024
    s_add_u32 s60, s60, 1
    buffer_load_dwordx4 v4, s[4:7], s52 offen lds
    s_add_u32 m0, m0, 1024
    s_and_b32 s60, s60, 7
    buffer_load_dwordx4 v5, s[4:7], s52 offen lds
    s_cmp_lg_u32 s43, 0
    s_mov_b32 m0, 41984
    s_cbranch_scc1 L_nohalo4
    buffer_load_dwordx4 v6, s[4:7], s68 offen lds
L_nohalo4:
    s_add_u32 s62, s81, 131072
    s_add_u32 s63, s80, 8
    s_lshl_b32 s63, s63, 15
    s_lshl3_add_u32 s46, s65, s63
    s_add_u32 m0, s65, s62
    s_and_b32 s46, s46, 0x7ffff
    s_add_u32 s65, s65, 4096
    buffer_load_dwordx4 v1, s[20:23], s46 offen lds
    s_and_b32 s65, s65, 0x7fff
    s_lshl3_add_u32 s46, s65, s63
    s_add_u32 m0, s65, s62
    s_and_b32 s46, s46, 0x7ffff
    s_add_u32 s65, s65, 4096
    buffer_load_dwordx4 v1, s[20:23], s46 offen lds
    s_and_b32 s65, s65, 0x7fff
    s_waitcnt vmcnt(14)
    s_barrier
    s_mul_i32 s47, s60, 196608
    s_add_u32 m0, s51, 83968
    s_add_u32 s53, s67, s47
    buffer_load_dwordx4 v7, s[8:11], s53 offen lds
    buffer_load_dwordx4 v7, s[8:11], s53 offen offset:1024 lds
    buffer_load_dwordx4 v7, s[8:11], s53 offen offset:2048 lds
    s_add_u32 m0, s51, 87040
    s_nop 0
    buffer_load_dwordx4 v8, s[8:11], s53 offen lds
    buffer_load_dwordx4 v8, s[8:11], s53 offen offset:1024 lds
    buffer_load_dwordx4 v8, s[8:11], s53 offen offset:2048 lds
    s_lshl_b32 s46, s60, 7
    s_add_u32 m0, s50, 83968
    s_add_u32 s52, s61, s46
    buffer_load_dwordx4 v2, s[4:7], s52 offen lds
    s_add_u32 m0, m0, 1024
    s_add_u32 s68, s66, s46
    buffer_load_dwordx4 v3, s[4:7], s52 offen lds
    s_add_u32 m0, m0, 1024
    s_add_u32 s60, s60, 1
    buffer_load_dwordx4 v4, s[4:7], s52 offen lds
    s_add_u32 m0, m0, 1024
    s_and_b32 s60, s60, 7
    buffer_load_dwordx4 v5, s[4:7], s52 offen lds
    s_cmp_lg_u32 s43, 0
    s_mov_b32 m0, 83968
    s_cbranch_scc1 L_nohalo5
    buffer_load_dwordx4 v6, s[4:7], s68 offen lds
L_nohalo5:
    s_lshl3_add_u32 s46, s65, s63
    s_add_u32 m0, s65, s62
    s_and_b32 s46, s46, 0x7ffff
    s_add_u32 s65, s65, 4096
    buffer_load_dwordx4 v1, s[20:23], s46 offen lds
    s_and_b32 s65, s65, 0x7fff
    s_lshl3_add_u32 s46, s65, s63
    s_add_u32 m0, s65, s62
    s_and_b32 s46, s46, 0x7ffff
    s_add_u32 s65, s65, 4096
    buffer_load_dwordx4 v1, s[20:23], s46 offen lds
    s_and_b32 s65, s65, 0x7fff
    s_waitcnt vmcnt(14)
    s_barrier
    s_mul_i32 s47, s60, 196608
    s_add_u32 m0, s51, 0
    s_add_u32 s53, s67, s47
    buffer_load_dwordx4 v7, s[8:11], s53 offen lds
    buffer_load_dwordx4 v7, s[8:11], s53 offen offset:1024 lds
    buffer_load_dwordx4 v7, s[8:11], s53 offen offset:2048 lds
    s_add_u32 m0, s51, 3072
    s_nop 0
    buffer_load_dwordx4 v8, s[8:11], s53 offen lds
    buffer_load_dwordx4 v8, s[8:11], s53 offen offset:1024 lds
    buffer_load_dwordx4 v8, s[8:11], s53 offen offset:2048 lds
    s_lshl_b32 s46, s60, 7
    s_add_u32 m0, s50, 0
    s_add_u32 s52, s61, s46
    buffer_load_dwordx4 v2, s[4:7], s52 offen lds
    s_add_u32 m0, m0, 1024
    s_add_u32 s68, s66, s46
    buffer_load_dwordx4 v3, s[4:7], s52 offen lds
    s_add_u32 m0, m0, 1024
    s_add_u32 s60, s60, 1
    buffer_load_dwordx4 v4, s[4:7], s52 offen lds
    s_add_u32 m0, m0, 1024
    s_and_b32 s60, s60, 7
    buffer_load_dwordx4 v5, s[4:7], s52 offen lds
    s_cmp_lg_u32 s43, 0
    s_mov_b32 m0, 0
    s_cbranch_scc1 L_nohalo6
    buffer_load_dwordx4 v6, s[4:7], s68 offen lds
L_nohalo6:
    s_lshl3_add_u32 s46, s65, s63
    s_add_u32 m0, s65, s62
    s_and_b32 s46, s46, 0x7ffff
    s_add_u32 s65, s65, 4096
    buffer_load_dwordx4 v1, s[20:23], s46 offen lds
    s_and_b32 s65, s65, 0x7fff
    s_lshl3_add_u32 s46, s65, s63
    s_add_u32 m0, s65, s62
    s_and_b32 s46, s46, 0x7ffff
    s_add_u32 s65, s65, 4096
    buffer_load_dwordx4 v1, s[20:23], s46 offen lds
    s_and_b32 s65, s65, 0x7fff
    s_waitcnt vmcnt(14)
    s_barrier
    s_mul_i32 s47, s60, 196608
    s_add_u32 m0, s51, 41984
    s_add_u32 s53, s67, s47
    buffer_load_dwordx4 v7, s[8:11], s53 offen lds
    buffer_load_dwordx4 v7, s[8:11], s53 offen offset:1024 lds
    buffer_load_dwordx4 v7, s[8:11], s53 offen offset:2048 lds
    s_add_u32 m0, s51, 45056
    s_nop 0
    buffer_load_dwordx4 v8, s[8:11], s53 offen lds
    buffer_load_dwordx4 v8, s[8:11], s53 offen offset:1024 lds
    buffer_load_dwordx4 v8, s[8:11], s53 offen offset:2048 lds
    s_lshl_b32 s46, s60, 7
    s_add_u32 m0, s50, 41984
    s_add_u32 s52, s61, s46
    buffer_load_dwordx4 v2, s[4:7], s52 offen lds
    s_add_u32 m0, m0, 1024
    s_add_u32 s68, s66, s46
    buffer_load_dwordx4 v3, s[4:7], s52 offen lds
    s_add_u32 m0, m0, 1024
    s_add_u32 s60, s60, 1
    buffer_load_dwordx4 v4, s[4:7], s52 offen lds
    s_add_u32 m0, m0, 1024
    s_and_b32 s60, s60, 7
    buffer_load_dwordx4 v5, s[4:7], s52 offen lds
    s_cmp_lg_u32 s43, 0
    s_mov_b32 m0, 41984
    s_cbranch_scc1 L_nohalo7
    buffer_load_dwordx4 v6, s[4:7], s68 offen lds
L_nohalo7:
    s_waitcnt vmcnt(12)
    s_barrier
    s_mov_b32 s45, 0
    buffer_store_dwordx4 v[40:43], v39, s[12:15], s45 offen sc1
    s_mov_b32 s45, 65536
    buffer_store_dwordx4 v[40:43], v39, s[12:15], s45 offen sc1
    s_mov_b32 s45, 131072
    buffer_store_dwordx4 v[40:43], v39, s[12:15], s45 offen sc1
    s_mov_b32 s45, 196608
    buffer_store_dwordx4 v[40:43], v39, s[12:15], s45 offen sc1
    s_mov_b32 exec_lo, 1
    s_mov_b32 exec_hi, 1
    buffer_store_dword v40, v32, s[12:15], 0 offen sc1
    s_mov_b64 exec, -1
    s_lshl3_add_u32 s46, s65, s63
    s_add_u32 m0, s65, s62
    s_and_b32 s46, s46, 0x7ffff
    s_add_u32 s65, s65, 4096
    buffer_load_dwordx4 v1, s[20:23], s46 offen lds
    s_and_b32 s65, s65, 0x7fff
    s_lshl3_add_u32 s46, s65, s63
    s_add_u32 m0, s65, s62
    s_and_b32 s46, s46, 0x7ffff
    s_add_u32 s65, s65, 4096
    buffer_load_dwordx4 v1, s[20:23], s46 offen lds
    s_and_b32 s65, s65, 0x7fff
    s_add_u32 s62, s81, 98304
    s_add_u32 s63, s80, 0
    s_lshl_b32 s63, s63, 15
    s_lshl3_add_u32 s46, s65, s63
    s_add_u32 m0, s65, s62
    s_and_b32 s46, s46, 0x7ffff
    s_add_u32 s65, s65, 4096
    buffer_load_dwordx4 v1, s[20:23], s46 offen lds
    s_and_b32 s65, s65, 0x7fff
    s_lshl3_add_u32 s46, s65, s63
    s_add_u32 m0, s65, s62
    s_and_b32 s46, s46, 0x7ffff
    s_add_u32 s65, s65, 4096
    buffer_load_dwordx4 v1, s[20:23], s46 offen lds
    s_and_b32 s65, s65, 0x7fff
    s_lshl3_add_u32 s46, s65, s63
    s_add_u32 m0, s65, s62
    s_and_b32 s46, s46, 0x7ffff
    s_add_u32 s65, s65, 4096
    buffer_load_dwordx4 v1, s[20:23], s46 offen lds
    s_and_b32 s65, s65, 0x7fff
    s_lshl3_add_u32 s46, s65, s63
    s_add_u32 m0, s65, s62
    s_and_b32 s46, s46, 0x7ffff
    s_add_u32 s65, s65, 4096
    buffer_load_dwordx4 v1, s[20:23], s46 offen lds
    s_and_b32 s65, s65, 0x7fff
    s_lshl3_add_u32 s46, s65, s63
    s_add_u32 m0, s65, s62
    s_and_b32 s46, s46, 0x7ffff
    s_add_u32 s65, s65, 4096
    buffer_load_dwordx4 v1, s[20:23], s46 offen lds
    s_and_b32 s65, s65, 0x7fff
    s_waitcnt vmcnt(12)
    s_barrier
    buffer_load_dword v12, v9, s[28:31], 0 offen offset:64 sc1
    s_lshl3_add_u32 s46, s65, s63
    s_add_u32 m0, s65, s62
    s_and_b32 s46, s46, 0x7ffff
    s_add_u32 s65, s65, 4096
    buffer_load_dwordx4 v1, s[20:23], s46 offen lds
    s_and_b32 s65, s65, 0x7fff
    s_lshl3_add_u32 s46, s65, s63
    s_add_u32 m0, s65, s62
    s_and_b32 s46, s46, 0x7ffff
    s_add_u32 s65, s65, 4096
    buffer_load_dwordx4 v1, s[20:23], s46 offen lds
    s_and_b32 s65, s65, 0x7fff
    s_lshl3_add_u32 s46, s65, s63
    s_add_u32 m0, s65, s62
    s_and_b32 s46, s46, 0x7ffff
    s_add_u32 s65, s65, 4096
    buffer_load_dwordx4 v1, s[20:23], s46 offen lds
    s_and_b32 s65, s65, 0x7fff
    s_add_u32 s62, s81, 0
    s_add_u32 s63, s80, 0
    s_lshl_b32 s63, s63, 15
    s_mov_b32 s48, 8
L_wo2:
    s_lshl3_add_u32 s46, s65, s63
    s_add_u32 m0, s65, s62
    s_and_b32 s46, s46, 0x7ffff
    s_add_u32 s65, s65, 4096
    buffer_load_dwordx4 v1, s[16:19], s46 offen lds
    s_and_b32 s65, s65, 0x7fff
    s_sub_u32 s48, s48, 1
    s_cmp_lg_u32 s48, 0
    s_cbranch_scc1 L_wo2
    v_mov_b32 v10, v37
    v_mov_b32 v11, v38
    v_mov_b32 v7, v47
    v_mov_b32 v5, v45
    s_waitcnt vmcnt(8)
    v_cmp_ne_u32 vcc, 0, v12
    s_nop 0
    s_cmp_eq_u64 vcc, -1
    s_cbranch_scc0 L_rst
L_rst_ok:
    v_mov_b32 v13, s69
    v_mov_b32 v14, 1
    s_barrier
    s_add_u32 s62, s81, 32768
    s_add_u32 s63, s80, 8
    s_lshl_b32 s63, s63, 15
    s_mov_b32 s48, 8
L_wo3:
    s_lshl3_add_u32 s46, s65, s63
    s_add_u32 m0, s65, s62
    s_and_b32 s46, s46, 0x7ffff
    s_add_u32 s65, s65, 4096
    buffer_load_dwordx4 v1, s[16:19], s46 offen lds
    s_and_b32 s65, s65, 0x7fff
    s_sub_u32 s48, s48, 1
    s_cmp_lg_u32 s48, 0
    s_cbranch_scc1 L_wo3
    buffer_load_dwordx4 v[16:19], v34, s[4:7], 0 offen
    buffer_load_dwordx4 v[20:23], v34, s[4:7], 0 offen offset:2048
    buffer_load_dwordx4 v[24:27], v35, s[32:35], 0 offen
    s_mov_b32 exec_lo, 1
    s_mov_b32 exec_hi, 0
    buffer_store_dword v14, v13, s[12:15], 0 offen sc1
    s_mov_b64 exec, -1
    v_mov_b32 v8, v32
    v_mov_b32 v1, v36
    s_branch L_p2pre
L_compute:
    s_lshr_b32 s39, s2, 3
    v_and_b32 v10, 15, v0
    v_lshrrev_b32 v11, 4, v0
    v_lshrrev_b32 v12, 1, v10
    v_xor_b32 v12, 4, v12
    v_xor_b32 v12, v11, v12
    v_lshlrev_b32 v13, 7, v10
    v_add_u32 v13, 1024, v13
    v_lshl_add_u32 v2, v12, 4, v13
    v_xor_b32 v3, 64, v2
    v_and_b32 v13, 7, v10
    v_lshrrev_b32 v12, 1, v13
    v_xor_b32 v12, v11, v12
    v_lshlrev_b32 v13, 7, v13
    v_lshl_add_u32 v4, v12, 4, v13
    v_xor_b32 v5, 64, v4
    v_lshrrev_b32 v12, 2, v10
    v_and_b32 v13, 3, v0
    v_mul_u32_u24 v14, 3072, v11
    v_lshl_add_u32 v14, v12, 7, v14
    v_lshl_add_u32 v14, v13, 3, v14
    v_lshrrev_b32 v12, 1, v12
    v_and_b32 v13, 1, v11
    v_lshl_add_u32 v12, v13, 1, v12
    v_xor_b32 v12, s43, v12
    v_lshl_add_u32 v14, v12, 5, v14
    v_add_u32 v6, 17408, v14
    v_mov_b32 v15, 0xff800000
    v_lshlrev_b32 v14, 2, v11
    v_sub_u32 v14, v14, v10
    s_and_b32 s44, s2, 0x31
    s_cmp_eq_u32 s44, 0
    s_cselect_b64 s[54:55], 0, -1
    v_cmp_le_i32 vcc, 9, v14
    v_add_u32 v12, 7, v14
    s_nop 0
    v_cndmask_b32 v16, v15, 0, vcc
    v_cndmask_b32 v8, 0, -1, vcc
    s_and_b64 vcc, vcc, s[54:55]
    v_cndmask_b32 v24, v15, 0, vcc
    v_cmp_gt_u32 vcc, 8, v12
    s_nop 1
    v_cndmask_b32 v20, v15, 0, vcc
    v_cmp_le_i32 vcc, 8, v14
    v_add_u32 v12, 8, v14
    s_nop 0
    v_cndmask_b32 v17, v15, 0, vcc
    v_cndmask_b32 v9, 0, -1, vcc
    s_and_b64 vcc, vcc, s[54:55]
    v_cndmask_b32 v25, v15, 0, vcc
    v_cmp_gt_u32 vcc, 8, v12
    s_nop 1
    v_cndmask_b32 v21, v15, 0, vcc
    v_and_b32 v8, 0xffff, v8
    v_and_b32 v9, 0xffff0000, v9
    v_or_b32 v28, v8, v9
    v_cmp_le_i32 vcc, 7, v14
    v_add_u32 v12, 9, v14
    s_nop 0
    v_cndmask_b32 v18, v15, 0, vcc
    v_cndmask_b32 v8, 0, -1, vcc
    s_and_b64 vcc, vcc, s[54:55]
    v_cndmask_b32 v26, v15, 0, vcc
    v_cmp_gt_u32 vcc, 8, v12
    s_nop 1
    v_cndmask_b32 v22, v15, 0, vcc
    v_cmp_le_i32 vcc, 6, v14
    v_add_u32 v12, 10, v14
    s_nop 0
    v_cndmask_b32 v19, v15, 0, vcc
    v_cndmask_b32 v9, 0, -1, vcc
    s_and_b64 vcc, vcc, s[54:55]
    v_cndmask_b32 v27, v15, 0, vcc
    v_cmp_gt_u32 vcc, 8, v12
    s_nop 1
    v_cndmask_b32 v23, v15, 0, vcc
    v_and_b32 v8, 0xffff, v8
    v_and_b32 v9, 0xffff0000, v9
    v_or_b32 v29, v8, v9
    v_not_b32 v8, v28
    v_not_b32 v9, v29
    v_mov_b32 v30, 0x3f803f80
    v_mov_b32 v31, 0x3f803f80
    s_load_dwordx2 s[12:13], s[0:1], 72
    s_load_dwordx2 s[24:25], s[0:1], 56
    s_mov_b32 s14, 16777216
    s_mov_b32 s15, 0x20000
    s_mov_b32 s26, 2097152
    s_mov_b32 s27, s15
    s_and_b32 s46, s2, 1
    s_lshl_b32 s46, s46, 3
    s_and_b32 s47, s39, 7
    s_add_u32 s36, s46, s47
    s_and_b32 s46, s2, 2
    s_and_b32 s47, s2, 4
    s_lshl2_add_u32 s46, s46, s47
    s_lshr_b32 s47, s39, 3
    s_add_u32 s37, s46, s47
    s_and_b32 s46, s2, 7
    s_lshl_b32 s46, s46, 2
    s_and_b32 s47, s39, 3
    s_add_u32 s46, s46, s47
    s_lshr_b32 s40, s46, 1
    s_and_b32 s41, s46, 1
    s_lshr_b32 s42, s39, 2
    s_lshr_b32 s57, s3, 2
    s_mul_i32 s80, s42, 2
    s_and_b32 s80, s80, 14
    s_mov_b32 s56, 1048576
    s_lshl2_add_u32 s44, s46, s43
    s_lshl_b32 s47, s44, 6
    s_add_u32 s47, s47, 4718592
    s_lshl_b32 s59, s44, 15
    s_lshl_b32 s45, s57, 14
    s_add_u32 s59, s59, s45
    s_lshl_b32 s64, s3, 11
    s_add_u32 s64, s64, 65536
    s_lshl_b32 s72, s80, 10
    s_add_u32 s73, s72, 2048
    s_and_b32 s73, s73, 0x3fff
    s_add_u32 s74, s73, 2048
    s_and_b32 s74, s74, 0x3fff
    s_add_u32 s75, s74, 2048
    s_and_b32 s75, s75, 0x3fff
    s_add_u32 s76, s75, 2048
    s_and_b32 s76, s76, 0x3fff
    s_add_u32 s77, s76, 2048
    s_and_b32 s77, s77, 0x3fff
    s_add_u32 s78, s77, 2048
    s_and_b32 s78, s78, 0x3fff
    s_add_u32 s79, s78, 2048
    s_and_b32 s79, s79, 0x3fff
    v_and_b32 v12, 1, v11
    v_lshrrev_b32 v13, 1, v11
    v_lshlrev_b32 v14, 15, v12
    v_lshl_add_u32 v14, v13, 8, v14
    v_lshl_add_u32 v14, v10, 4, v14
    s_lshl_b32 s44, s36, 18
    s_lshl_b32 s45, s37, 11
    s_add_u32 s44, s44, s45
    s_lshl_b32 s45, s43, 9
    s_add_u32 s44, s44, s45
    v_add_u32 v7, s44, v14
    v_lshlrev_b32 v14, 5, v12
    v_lshl_add_u32 v14, v13, 4, v14
    v_lshl_add_u32 v14, v10, 11, v14
    s_lshr_b32 s44, s40, 1
    s_lshl_b32 s44, s44, 8
    s_and_b32 s45, s40, 1
    s_add_u32 s44, s44, s45
    s_lshl_b32 s45, s41, 7
    s_add_u32 s44, s44, s45
    s_lshl_b32 s45, s43, 5
    s_add_u32 s44, s44, s45
    s_lshl_b32 s44, s44, 10
    s_lshl1_add_u32 s45, s42, s57
    s_lshl_b32 s45, s45, 6
    s_add_u32 s44, s44, s45
    v_xor_b32 v12, s57, v12
    v_lshrrev_b32 v15, 2, v10
    v_lshrrev_b32 v13, 1, v15
    v_lshl_add_u32 v12, v12, 1, v13
    v_lshlrev_b32 v12, 5, v12
    v_lshl_add_u32 v12, v15, 7, v12
    v_lshl_add_u32 v12, v11, 10, v12
    v_and_b32 v13, 3, v0
    v_lshl_add_u32 v12, v13, 3, v12
    s_mul_i32 s45, s57, 98304
    v_add_u32 v1, s45, v12
    v_lshl_add_u32 v11, v0, 2, s47
    v_add_u32 v10, s44, v14
    v_mov_b64 v[32:33], 0
    v_mov_b64 v[34:35], 0
    v_mov_b64 v[36:37], 0
    v_mov_b64 v[38:39], 0
    v_mov_b64 v[40:41], 0
    v_mov_b64 v[42:43], 0
    v_mov_b64 v[44:45], 0
    v_mov_b64 v[46:47], 0
    v_mov_b64 v[48:49], 0
    v_mov_b64 v[50:51], 0
    v_mov_b64 v[52:53], 0
    v_mov_b64 v[54:55], 0
    v_mov_b64 v[56:57], 0
    v_mov_b64 v[58:59], 0
    v_mov_b64 v[60:61], 0
    v_mov_b64 v[62:63], 0
    v_mov_b64 v[64:65], 0
    v_mov_b64 v[66:67], 0
    v_mov_b64 v[68:69], 0
    v_mov_b64 v[70:71], 0
    v_mov_b64 v[72:73], 0
    v_mov_b64 v[74:75], 0
    v_mov_b64 v[76:77], 0
    v_mov_b64 v[78:79], 0
    v_mov_b64 v[80:81], 0
    v_mov_b64 v[82:83], 0
    v_mov_b64 v[84:85], 0
    v_mov_b64 v[86:87], 0
    v_mov_b64 v[88:89], 0
    v_mov_b64 v[90:91], 0
    v_mov_b64 v[92:93], 0
    v_mov_b64 v[94:95], 0
    v_mov_b64 v[96:97], 0
    v_mov_b64 v[98:99], 0
    v_mov_b64 v[100:101], 0
    v_mov_b64 v[102:103], 0
    v_mov_b64 v[104:105], 0
    v_mov_b64 v[106:107], 0
    v_mov_b64 v[108:109], 0
    v_mov_b64 v[110:111], 0
    v_mov_b64 v[112:113], 0
    v_mov_b64 v[114:115], 0
    v_mov_b64 v[116:117], 0
    v_mov_b64 v[118:119], 0
    v_mov_b64 v[120:121], 0
    v_mov_b64 v[122:123], 0
    v_mov_b64 v[124:125], 0
    v_mov_b64 v[126:127], 0
    v_mov_b64 v[128:129], 0
    v_mov_b64 v[130:131], 0
    v_mov_b64 v[132:133], 0
    v_mov_b64 v[134:135], 0
    s_mov_b32 s70, 0x3eb8aa3b
    s_mov_b32 s71, 0x3eb8aa3b
    s_mov_b32 s48, 0
    s_mov_b32 s49, 0
    s_mov_b32 s50, 41984
    s_mov_b32 s45, 0x10000
    s_mov_b32 s46, 0x20000
    s_mov_b32 s47, 0x30000
    s_waitcnt vmcnt(0) lgkmcnt(0)
    s_mov_b32 s10, 1572864
    s_mov_b32 s11, 0x20000
    s_and_b32 s44, s2, 4
    s_or_b32 s44, s44, s43
    s_cselect_b32 s44, 24, s39
    s_lshl_b32 s44, s44, 16
    v_lshl_add_u32 v12, v0, 10, s44
    s_cmp_lg_u32 s43, 0
    s_waitcnt lgkmcnt(0)
    s_cbranch_scc1 L_nopf3
    buffer_load_dword v255, v12, s[8:11], 0 offen offset:384
L_nopf3:
    s_barrier
    ds_read_b64_tr_b16 v[176:177], v6 offset:1024
    ds_read_b64_tr_b16 v[178:179], v6 offset:1536
    ds_read_b128 v[136:139], v4
    ds_read_b64_tr_b16 v[172:173], v6 offset:0
    ds_read_b64_tr_b16 v[174:175], v6 offset:512
    ds_read_b64_tr_b16 v[180:181], v6 offset:2048
    ds_read_b64_tr_b16 v[182:183], v6 offset:2560
    ds_read_b128 v[140:143], v2 offset:0
    ds_read_b128 v[144:147], v2 offset:2048
    ds_read_b128 v[148:151], v2 offset:4096
    ds_read_b128 v[152:155], v2 offset:6144
    ds_read_b128 v[156:159], v2 offset:8192
    ds_read_b128 v[160:163], v2 offset:10240
    ds_read_b128 v[164:167], v2 offset:12288
    ds_read_b128 v[168:171], v2 offset:14336
    .p2align 6
L_gemm:
    s_waitcnt lgkmcnt(0)
    v_mfma_f32_16x16x32_bf16 v[32:35], v[176:179], v[136:139], v[32:35]
    ds_read_b64_tr_b16 v[224:225], v6 offset:13312
    v_mfma_f32_16x16x32_bf16 v[68:71], v[136:139], v[180:183], v[68:71]
    ds_read_b64_tr_b16 v[226:227], v6 offset:13824
    v_mfma_f32_16x16x32_bf16 v[36:39], v[176:179], v[140:143], v[36:39]
    ds_read_b128 v[184:187], v5
    v_mfma_f32_16x16x32_bf16 v[104:107], v[172:175], v[140:143], v[104:107]
    ds_read_b64_tr_b16 v[220:221], v6 offset:12288
    v_mfma_f32_16x16x32_bf16 v[72:75], v[140:143], v[180:183], v[72:75]
    ds_read_b64_tr_b16 v[222:223], v6 offset:12800
    v_mfma_f32_16x16x32_bf16 v[40:43], v[176:179], v[144:147], v[40:43]
    ds_read_b64_tr_b16 v[228:229], v6 offset:14336
    v_mfma_f32_16x16x32_bf16 v[108:111], v[172:175], v[144:147], v[108:111]
    ds_read_b64_tr_b16 v[230:231], v6 offset:14848
    v_mfma_f32_16x16x32_bf16 v[76:79], v[144:147], v[180:183], v[76:79]
    ds_read_b128 v[188:191], v3 offset:0
    v_mfma_f32_16x16x32_bf16 v[44:47], v[176:179], v[148:151], v[44:47]
    ds_read_b128 v[192:195], v3 offset:2048
    v_mfma_f32_16x16x32_bf16 v[112:115], v[172:175], v[148:151], v[112:115]
    ds_read_b128 v[196:199], v3 offset:4096
    v_mfma_f32_16x16x32_bf16 v[80:83], v[148:151], v[180:183], v[80:83]
    ds_read_b128 v[200:203], v3 offset:6144
    v_mfma_f32_16x16x32_bf16 v[48:51], v[176:179], v[152:155], v[48:51]
    ds_read_b128 v[204:207], v3 offset:8192
    v_mfma_f32_16x16x32_bf16 v[116:119], v[172:175], v[152:155], v[116:119]
    ds_read_b128 v[208:211], v3 offset:10240
    v_mfma_f32_16x16x32_bf16 v[84:87], v[152:155], v[180:183], v[84:87]
    ds_read_b128 v[212:215], v3 offset:12288
    v_mfma_f32_16x16x32_bf16 v[52:55], v[176:179], v[156:159], v[52:55]
    ds_read_b128 v[216:219], v3 offset:14336
    v_mfma_f32_16x16x32_bf16 v[120:123], v[172:175], v[156:159], v[120:123]
    s_add_u32 s49, s49, 1
    v_mfma_f32_16x16x32_bf16 v[88:91], v[156:159], v[180:183], v[88:91]
    s_cmp_eq_u32 s49, 3
    v_mfma_f32_16x16x32_bf16 v[56:59], v[176:179], v[160:163], v[56:59]
    s_cselect_b32 s44, -83968, s50
    v_mfma_f32_16x16x32_bf16 v[124:127], v[172:175], v[160:163], v[124:127]
    s_cselect_b32 s49, 0, s49
    v_mfma_f32_16x16x32_bf16 v[92:95], v[160:163], v[180:183], v[92:95]
    v_mfma_f32_16x16x32_bf16 v[60:63], v[176:179], v[164:167], v[60:63]
    v_mfma_f32_16x16x32_bf16 v[128:131], v[172:175], v[164:167], v[128:131]
    v_mfma_f32_16x16x32_bf16 v[96:99], v[164:167], v[180:183], v[96:99]
    v_mfma_f32_16x16x32_bf16 v[64:67], v[176:179], v[168:171], v[64:67]
    v_mfma_f32_16x16x32_bf16 v[132:135], v[172:175], v[168:171], v[132:135]
    v_mfma_f32_16x16x32_bf16 v[100:103], v[168:171], v[180:183], v[100:103]
L_mid:
    s_waitcnt lgkmcnt(0)
    s_barrier
    v_mfma_f32_16x16x32_bf16 v[32:35], v[224:227], v[184:187], v[32:35]
    v_add_u32 v6, s44, v6
    v_mfma_f32_16x16x32_bf16 v[68:71], v[184:187], v[228:231], v[68:71]
    v_add_u32 v4, s44, v4
    v_mfma_f32_16x16x32_bf16 v[36:39], v[224:227], v[188:191], v[36:39]
    v_add_u32 v2, s44, v2
    v_mfma_f32_16x16x32_bf16 v[104:107], v[220:223], v[188:191], v[104:107]
    ds_read_b64_tr_b16 v[176:177], v6 offset:1024
    v_mfma_f32_16x16x32_bf16 v[72:75], v[188:191], v[228:231], v[72:75]
    ds_read_b64_tr_b16 v[178:179], v6 offset:1536
    v_mfma_f32_16x16x32_bf16 v[40:43], v[224:227], v[192:195], v[40:43]
    ds_read_b128 v[136:139], v4
    v_mfma_f32_16x16x32_bf16 v[108:111], v[220:223], v[192:195], v[108:111]
    ds_read_b64_tr_b16 v[172:173], v6 offset:0
    v_mfma_f32_16x16x32_bf16 v[76:79], v[192:195], v[228:231], v[76:79]
    ds_read_b64_tr_b16 v[174:175], v6 offset:512
    v_mfma_f32_16x16x32_bf16 v[44:47], v[224:227], v[196:199], v[44:47]
    ds_read_b64_tr_b16 v[180:181], v6 offset:2048
    v_mfma_f32_16x16x32_bf16 v[112:115], v[220:223], v[196:199], v[112:115]
    ds_read_b64_tr_b16 v[182:183], v6 offset:2560
    v_mfma_f32_16x16x32_bf16 v[80:83], v[196:199], v[228:231], v[80:83]
    ds_read_b128 v[140:143], v2 offset:0
    v_mfma_f32_16x16x32_bf16 v[48:51], v[224:227], v[200:203], v[48:51]
    ds_read_b128 v[144:147], v2 offset:2048
    v_mfma_f32_16x16x32_bf16 v[116:119], v[220:223], v[200:203], v[116:119]
    ds_read_b128 v[148:151], v2 offset:4096
    v_mfma_f32_16x16x32_bf16 v[84:87], v[200:203], v[228:231], v[84:87]
    ds_read_b128 v[152:155], v2 offset:6144
    v_mfma_f32_16x16x32_bf16 v[52:55], v[224:227], v[204:207], v[52:55]
    ds_read_b128 v[156:159], v2 offset:8192
    v_mfma_f32_16x16x32_bf16 v[120:123], v[220:223], v[204:207], v[120:123]
    ds_read_b128 v[160:163], v2 offset:10240
    v_mfma_f32_16x16x32_bf16 v[88:91], v[204:207], v[228:231], v[88:91]
    ds_read_b128 v[164:167], v2 offset:12288
    v_mfma_f32_16x16x32_bf16 v[56:59], v[224:227], v[208:211], v[56:59]
    ds_read_b128 v[168:171], v2 offset:14336
    v_mfma_f32_16x16x32_bf16 v[124:127], v[220:223], v[208:211], v[124:127]
    v_add_u32 v5, s44, v5
    v_mfma_f32_16x16x32_bf16 v[92:95], v[208:211], v[228:231], v[92:95]
    v_add_u32 v3, s44, v3
    v_mfma_f32_16x16x32_bf16 v[60:63], v[224:227], v[212:215], v[60:63]
    s_add_u32 s48, s48, 1
    v_mfma_f32_16x16x32_bf16 v[128:131], v[220:223], v[212:215], v[128:131]
    s_cmp_lt_u32 s48, 7
    v_mfma_f32_16x16x32_bf16 v[96:99], v[212:215], v[228:231], v[96:99]
    v_mfma_f32_16x16x32_bf16 v[64:67], v[224:227], v[216:219], v[64:67]
    v_mfma_f32_16x16x32_bf16 v[132:135], v[220:223], v[216:219], v[132:135]
    v_mfma_f32_16x16x32_bf16 v[100:103], v[216:219], v[228:231], v[100:103]
    s_cbranch_scc1 L_gemm
    s_waitcnt vmcnt(0) lgkmcnt(0)
    v_mfma_f32_16x16x32_bf16 v[32:35], v[176:179], v[136:139], v[32:35]
    ds_read_b64_tr_b16 v[224:225], v6 offset:13312
    v_mfma_f32_16x16x32_bf16 v[36:39], v[176:179], v[140:143], v[36:39]
    ds_read_b64_tr_b16 v[226:227], v6 offset:13824
    v_mfma_f32_16x16x32_bf16 v[104:107], v[172:175], v[140:143], v[104:107]
    ds_read_b128 v[184:187], v5
    v_mfma_f32_16x16x32_bf16 v[40:43], v[176:179], v[144:147], v[40:43]
    ds_read_b64_tr_b16 v[220:221], v6 offset:12288
    v_mfma_f32_16x16x32_bf16 v[108:111], v[172:175], v[144:147], v[108:111]
    ds_read_b64_tr_b16 v[222:223], v6 offset:12800
    v_mfma_f32_16x16x32_bf16 v[44:47], v[176:179], v[148:151], v[44:47]
    ds_read_b64_tr_b16 v[228:229], v6 offset:14336
    v_mfma_f32_16x16x32_bf16 v[112:115], v[172:175], v[148:151], v[112:115]
    ds_read_b64_tr_b16 v[230:231], v6 offset:14848
    v_mfma_f32_16x16x32_bf16 v[48:51], v[176:179], v[152:155], v[48:51]
    ds_read_b128 v[188:191], v3 offset:0
    v_mfma_f32_16x16x32_bf16 v[116:119], v[172:175], v[152:155], v[116:119]
    ds_read_b128 v[192:195], v3 offset:2048
    v_mfma_f32_16x16x32_bf16 v[84:87], v[152:155], v[180:183], v[84:87]
    ds_read_b128 v[196:199], v3 offset:4096
    v_mfma_f32_16x16x32_bf16 v[72:75], v[140:143], v[180:183], v[72:75]
    ds_read_b128 v[200:203], v3 offset:6144
    v_mfma_f32_16x16x32_bf16 v[76:79], v[144:147], v[180:183], v[76:79]
    ds_read_b128 v[204:207], v3 offset:8192
    v_mfma_f32_16x16x32_bf16 v[68:71], v[136:139], v[180:183], v[68:71]
    ds_read_b128 v[208:211], v3 offset:10240
    v_mfma_f32_16x16x32_bf16 v[80:83], v[148:151], v[180:183], v[80:83]
    ds_read_b128 v[212:215], v3 offset:12288
    v_mfma_f32_16x16x32_bf16 v[52:55], v[176:179], v[156:159], v[52:55]
    ds_read_b128 v[216:219], v3 offset:14336
    v_mfma_f32_16x16x32_bf16 v[120:123], v[172:175], v[156:159], v[120:123]
    v_mfma_f32_16x16x32_bf16 v[56:59], v[176:179], v[160:163], v[56:59]
    v_mfma_f32_16x16x32_bf16 v[124:127], v[172:175], v[160:163], v[124:127]
    v_mfma_f32_16x16x32_bf16 v[60:63], v[176:179], v[164:167], v[60:63]
    v_mfma_f32_16x16x32_bf16 v[128:131], v[172:175], v[164:167], v[128:131]
    v_mfma_f32_16x16x32_bf16 v[64:67], v[176:179], v[168:171], v[64:67]
    v_mfma_f32_16x16x32_bf16 v[132:135], v[172:175], v[168:171], v[132:135]
    v_mfma_f32_16x16x32_bf16 v[88:91], v[156:159], v[180:183], v[88:91]
    v_mfma_f32_16x16x32_bf16 v[92:95], v[160:163], v[180:183], v[92:95]
    s_waitcnt lgkmcnt(0)
    v_mfma_f32_16x16x32_bf16 v[32:35], v[224:227], v[184:187], v[32:35]
    v_mfma_f32_16x16x32_bf16 v[36:39], v[224:227], v[188:191], v[36:39]
    v_mfma_f32_16x16x32_bf16 v[104:107], v[220:223], v[188:191], v[104:107]
    v_mfma_f32_16x16x32_bf16 v[40:43], v[224:227], v[192:195], v[40:43]
    v_mfma_f32_16x16x32_bf16 v[108:111], v[220:223], v[192:195], v[108:111]
    v_mfma_f32_16x16x32_bf16 v[44:47], v[224:227], v[196:199], v[44:47]
    v_mfma_f32_16x16x32_bf16 v[112:115], v[220:223], v[196:199], v[112:115]
    v_mfma_f32_16x16x32_bf16 v[48:51], v[224:227], v[200:203], v[48:51]
    s_nop 0
    v_cvt_pk_bf16_f32 v232, v32, v33
    v_mfma_f32_16x16x32_bf16 v[116:119], v[220:223], v[200:203], v[116:119]
    v_cvt_pk_bf16_f32 v233, v34, v35
    v_cvt_pk_bf16_f32 v234, v36, v37
    v_mfma_f32_16x16x32_bf16 v[72:75], v[188:191], v[228:231], v[72:75]
    v_cvt_pk_bf16_f32 v235, v38, v39
    v_cvt_pk_bf16_f32 v242, v104, v105
    v_mfma_f32_16x16x32_bf16 v[76:79], v[192:195], v[228:231], v[76:79]
    v_cvt_pk_bf16_f32 v243, v106, v107
    v_cvt_pk_bf16_f32 v236, v40, v41
    v_mfma_f32_16x16x32_bf16 v[68:71], v[184:187], v[228:231], v[68:71]
    v_cvt_pk_bf16_f32 v237, v42, v43
    v_cvt_pk_bf16_f32 v244, v108, v109
    v_mfma_f32_16x16x16_bf16 v[36:39], v[232:233], v[242:243], v[24:27]
    v_cvt_pk_bf16_f32 v245, v110, v111
    v_cvt_pk_bf16_f32 v238, v44, v45
    v_mfma_f32_16x16x16_bf16 v[104:107], v[234:235], v[242:243], v[20:23]
    v_cvt_pk_bf16_f32 v239, v46, v47
    v_cvt_pk_bf16_f32 v246, v112, v113
    v_mfma_f32_16x16x16_bf16 v[40:43], v[234:235], v[244:245], v[16:19]
    v_cvt_pk_bf16_f32 v247, v114, v115
    v_cvt_pk_bf16_f32 v240, v48, v49
    v_mfma_f32_16x16x16_bf16 v[108:111], v[236:237], v[244:245], v[20:23]
    v_cvt_pk_bf16_f32 v241, v50, v51
    v_cvt_pk_bf16_f32 v248, v116, v117
    v_mfma_f32_16x16x16_bf16 v[44:47], v[236:237], v[246:247], v[16:19]
    v_cvt_pk_bf16_f32 v249, v118, v119
    v_max_f32 v36, v36, v104
    v_mfma_f32_16x16x16_bf16 v[112:115], v[238:239], v[246:247], v[20:23]
    v_max_f32 v37, v37, v105
    v_max_f32 v38, v38, v106
    v_mfma_f32_16x16x16_bf16 v[48:51], v[238:239], v[248:249], v[16:19]
    v_max_f32 v40, v40, v108
    v_max_f32 v41, v41, v109
    v_mfma_f32_16x16x16_bf16 v[116:119], v[240:241], v[248:249], v[20:23]
    v_max_f32 v42, v42, v110
    v_max_f32 v39, v39, v107
    v_mfma_f32_16x16x32_bf16 v[80:83], v[196:199], v[228:231], v[80:83]
    v_max_f32 v44, v44, v112
    v_max_f32 v45, v45, v113
    v_mfma_f32_16x16x32_bf16 v[84:87], v[200:203], v[228:231], v[84:87]
    v_max_f32 v46, v46, v114
    v_max3_f32 v232, v36, v37, v38
    v_mfma_f32_16x16x32_bf16 v[52:55], v[224:227], v[204:207], v[52:55]
    v_max_f32 v48, v48, v116
    v_max_f32 v49, v49, v117
    v_mfma_f32_16x16x32_bf16 v[120:123], v[220:223], v[204:207], v[120:123]
    v_max_f32 v50, v50, v118
    v_max_f32 v43, v43, v111
    v_mfma_f32_16x16x32_bf16 v[56:59], v[224:227], v[208:211], v[56:59]
    v_max3_f32 v234, v40, v41, v42
    v_max_f32 v47, v47, v115
    v_mfma_f32_16x16x32_bf16 v[124:127], v[220:223], v[208:211], v[124:127]
    v_max3_f32 v236, v44, v45, v46
    v_max_f32 v51, v51, v119
    v_mfma_f32_16x16x32_bf16 v[60:63], v[224:227], v[212:215], v[60:63]
    v_max3_f32 v238, v48, v49, v50
    v_max_f32 v232, v232, v39
    v_mfma_f32_16x16x32_bf16 v[128:131], v[220:223], v[212:215], v[128:131]
    v_max_f32 v234, v234, v43
    v_max_f32 v236, v236, v47
    v_mfma_f32_16x16x32_bf16 v[64:67], v[224:227], v[216:219], v[64:67]
    s_barrier
    v_max_f32 v238, v238, v51
    v_permlane32_swap_b32 v232, v234
    v_mfma_f32_16x16x32_bf16 v[132:135], v[220:223], v[216:219], v[132:135]
    v_permlane32_swap_b32 v236, v238
    v_mfma_f32_16x16x32_bf16 v[96:99], v[164:167], v[180:183], v[96:99]
    v_max_f32 v232, v232, v234
    v_max_f32 v236, v236, v238
    v_mfma_f32_16x16x32_bf16 v[100:103], v[168:171], v[180:183], v[100:103]
    v_cvt_pk_bf16_f32 v138, v72, v73
    v_permlane16_swap_b32 v232, v236
    v_mfma_f32_16x16x32_bf16 v[88:91], v[204:207], v[228:231], v[88:91]
    v_max_f32 v232, v232, v236
    v_mul_f32 v232, s70, v232
    v_mfma_f32_16x16x32_bf16 v[92:95], v[208:211], v[228:231], v[92:95]
    v_mov_b32 v236, v232
    v_cvt_pk_bf16_f32 v139, v74, v75
    v_mfma_f32_16x16x32_bf16 v[96:99], v[212:215], v[228:231], v[96:99]
    v_permlane16_swap_b32 v232, v236
    v_mfma_f32_16x16x32_bf16 v[100:103], v[216:219], v[228:231], v[100:103]
    v_mov_b32 v234, v232
    v_mov_b32 v238, v236
    v_cvt_pk_bf16_f32 v140, v76, v77
    v_permlane32_swap_b32 v232, v234
    v_permlane32_swap_b32 v236, v238
    v_pk_fma_f32 v[36:37], v[36:37], s[70:71], v[232:233] op_sel_hi:[1,1,0] neg_lo:[0,0,1] neg_hi:[0,0,1]
    v_pk_fma_f32 v[38:39], v[38:39], s[70:71], v[232:233] op_sel_hi:[1,1,0] neg_lo:[0,0,1] neg_hi:[0,0,1]
    v_pk_fma_f32 v[40:41], v[40:41], s[70:71], v[234:235] op_sel_hi:[1,1,0] neg_lo:[0,0,1] neg_hi:[0,0,1]
    v_pk_fma_f32 v[42:43], v[42:43], s[70:71], v[234:235] op_sel_hi:[1,1,0] neg_lo:[0,0,1] neg_hi:[0,0,1]
    v_exp_f32 v36, v36
    v_exp_f32 v37, v37
    v_exp_f32 v38, v38
    v_exp_f32 v39, v39
    v_exp_f32 v40, v40
    v_exp_f32 v41, v41
    v_exp_f32 v42, v42
    v_exp_f32 v43, v43
    v_pk_fma_f32 v[44:45], v[44:45], s[70:71], v[236:237] op_sel_hi:[1,1,0] neg_lo:[0,0,1] neg_hi:[0,0,1]
    v_pk_fma_f32 v[46:47], v[46:47], s[70:71], v[236:237] op_sel_hi:[1,1,0] neg_lo:[0,0,1] neg_hi:[0,0,1]
    v_pk_fma_f32 v[48:49], v[48:49], s[70:71], v[238:239] op_sel_hi:[1,1,0] neg_lo:[0,0,1] neg_hi:[0,0,1]
    v_pk_fma_f32 v[50:51], v[50:51], s[70:71], v[238:239] op_sel_hi:[1,1,0] neg_lo:[0,0,1] neg_hi:[0,0,1]
    v_exp_f32 v44, v44
    v_exp_f32 v45, v45
    v_exp_f32 v46, v46
    v_exp_f32 v47, v47
    v_exp_f32 v48, v48
    v_exp_f32 v49, v49
    v_exp_f32 v50, v50
    v_exp_f32 v51, v51
    v_cvt_pk_bf16_f32 v242, v36, v37
    v_cvt_pk_bf16_f32 v243, v38, v39
    v_cvt_pk_bf16_f32 v244, v40, v41
    v_cvt_pk_bf16_f32 v245, v42, v43
    v_mfma_f32_16x16x16_bf16 v[104:107], v[30:31], v[242:243], 0
    v_cvt_pk_bf16_f32 v246, v44, v45
    v_cvt_pk_bf16_f32 v247, v46, v47
    v_mfma_f32_16x16x16_bf16 v[108:111], v[30:31], v[244:245], 0
    v_cvt_pk_bf16_f32 v248, v48, v49
    v_cvt_pk_bf16_f32 v249, v50, v51
    v_mfma_f32_16x16x16_bf16 v[112:115], v[30:31], v[246:247], 0
    v_cvt_pk_bf16_f32 v141, v78, v79
    v_cvt_pk_bf16_f32 v136, v68, v69
    v_mfma_f32_16x16x16_bf16 v[116:119], v[30:31], v[248:249], 0
    v_cvt_pk_bf16_f32 v137, v70, v71
    v_cvt_pk_bf16_f32 v142, v80, v81
    v_cvt_pk_bf16_f32 v143, v82, v83
    v_cvt_pk_bf16_f32 v144, v84, v85
    v_cvt_pk_bf16_f32 v145, v86, v87
    v_and_b32 v72, v28, v242
    v_and_b32 v73, v29, v243
    v_and_b32 v74, v8, v242
    v_and_b32 v75, v9, v243
    v_and_b32 v76, v28, v244
    v_and_b32 v77, v29, v245
    v_mfma_f32_16x16x32_bf16 v[36:39], v[136:139], v[72:75], 0
    v_and_b32 v78, v8, v244
    v_and_b32 v79, v9, v245
    v_and_b32 v80, v28, v246
    v_and_b32 v81, v29, v247
    v_mfma_f32_16x16x32_bf16 v[40:43], v[138:141], v[76:79], 0
    v_and_b32 v82, v8, v246
    v_and_b32 v83, v9, v247
    v_and_b32 v84, v28, v248
    v_and_b32 v85, v29, v249
    v_mfma_f32_16x16x32_bf16 v[44:47], v[140:143], v[80:83], 0
    v_and_b32 v86, v8, v248
    v_and_b32 v87, v9, v249
    v_cvt_pk_bf16_f32 v172, v52, v53
    v_cvt_pk_bf16_f32 v173, v54, v55
    v_mfma_f32_16x16x32_bf16 v[48:51], v[142:145], v[84:87], 0
    v_cvt_pk_bf16_f32 v12, v120, v121
    v_cvt_pk_bf16_f32 v13, v122, v123
    v_cvt_pk_bf16_f32 v174, v56, v57
    v_cvt_pk_bf16_f32 v175, v58, v59
    v_mfma_f32_16x16x16_bf16 v[52:55], v[240:241], v[12:13], v[16:19]
    v_cvt_pk_bf16_f32 v14, v124, v125
    v_cvt_pk_bf16_f32 v15, v126, v127
    v_mfma_f32_16x16x16_bf16 v[120:123], v[172:173], v[12:13], v[20:23]
    v_cvt_pk_bf16_f32 v176, v60, v61
    v_cvt_pk_bf16_f32 v177, v62, v63
    v_mfma_f32_16x16x16_bf16 v[56:59], v[172:173], v[14:15], v[16:19]
    v_cvt_pk_bf16_f32 v254, v128, v129
    v_cvt_pk_bf16_f32 v255, v130, v131
    v_mfma_f32_16x16x16_bf16 v[124:127], v[174:175], v[14:15], v[20:23]
    v_cvt_pk_bf16_f32 v178, v64, v65
    v_cvt_pk_bf16_f32 v179, v66, v67
    v_mfma_f32_16x16x16_bf16 v[60:63], v[174:175], v[254:255], v[16:19]
    v_cvt_pk_bf16_f32 v154, v132, v133
    v_cvt_pk_bf16_f32 v155, v134, v135
    v_mfma_f32_16x16x16_bf16 v[128:131], v[176:177], v[254:255], v[20:23]
    v_rcp_f32 v104, v104
    v_mfma_f32_16x16x16_bf16 v[64:67], v[176:177], v[154:155], v[16:19]
    v_rcp_f32 v108, v108
    v_mfma_f32_16x16x16_bf16 v[132:135], v[178:179], v[154:155], v[20:23]
    v_rcp_f32 v112, v112
    v_rcp_f32 v116, v116
    v_pk_mul_f32 v[36:37], v[36:37], v[104:105] op_sel_hi:[1,0]
    v_pk_mul_f32 v[38:39], v[38:39], v[104:105] op_sel_hi:[1,0]
    v_pk_mul_f32 v[40:41], v[40:41], v[108:109] op_sel_hi:[1,0]
    v_pk_mul_f32 v[42:43], v[42:43], v[108:109] op_sel_hi:[1,0]
    v_cvt_pk_bf16_f32 v32, v36, v37
    v_cvt_pk_bf16_f32 v33, v38, v39
    v_cvt_pk_bf16_f32 v34, v40, v41
    v_cvt_pk_bf16_f32 v35, v42, v43
    v_pk_mul_f32 v[44:45], v[44:45], v[112:113] op_sel_hi:[1,0]
    v_pk_mul_f32 v[46:47], v[46:47], v[112:113] op_sel_hi:[1,0]
    v_pk_mul_f32 v[48:49], v[48:49], v[116:117] op_sel_hi:[1,0]
    v_pk_mul_f32 v[50:51], v[50:51], v[116:117] op_sel_hi:[1,0]
    v_cvt_pk_bf16_f32 v250, v44, v45
    v_cvt_pk_bf16_f32 v251, v46, v47
    v_cvt_pk_bf16_f32 v252, v48, v49
    v_cvt_pk_bf16_f32 v253, v50, v51
    v_permlane16_swap_b32 v32, v34
    v_permlane16_swap_b32 v33, v35
    v_permlane16_swap_b32 v250, v252
    v_permlane16_swap_b32 v251, v253
    buffer_store_dwordx4 v[32:35], v7, s[12:15], 0 offen sc1
    buffer_store_dwordx4 v[250:253], v7, s[12:15], s45 offen sc1
    v_max_f32 v52, v52, v120
    v_max_f32 v53, v53, v121
    v_max_f32 v54, v54, v122
    v_max_f32 v56, v56, v124
    v_max_f32 v57, v57, v125
    v_max_f32 v58, v58, v126
    v_max_f32 v60, v60, v128
    v_max_f32 v61, v61, v129
    v_max_f32 v62, v62, v130
    v_max_f32 v64, v64, v132
    v_max_f32 v65, v65, v133
    v_max_f32 v66, v66, v134
    v_max_f32 v55, v55, v123
    v_max3_f32 v240, v52, v53, v54
    v_max_f32 v59, v59, v127
    v_max3_f32 v172, v56, v57, v58
    v_max_f32 v63, v63, v131
    v_max3_f32 v174, v60, v61, v62
    v_max_f32 v67, v67, v135
    v_max3_f32 v176, v64, v65, v66
    v_max_f32 v240, v240, v55
    v_max_f32 v172, v172, v59
    v_max_f32 v174, v174, v63
    v_max_f32 v176, v176, v67
    v_permlane32_swap_b32 v240, v172
    v_max_f32 v240, v240, v172
    v_permlane32_swap_b32 v174, v176
    v_max_f32 v174, v174, v176
    v_cvt_pk_bf16_f32 v146, v88, v89
    v_cvt_pk_bf16_f32 v147, v90, v91
    v_permlane16_swap_b32 v240, v174
    v_max_f32 v240, v240, v174
    v_mul_f32 v240, s70, v240
    v_mov_b32 v174, v240
    v_cvt_pk_bf16_f32 v148, v92, v93
    v_cvt_pk_bf16_f32 v149, v94, v95
    v_permlane16_swap_b32 v240, v174
    v_mov_b32 v172, v240
    v_mov_b32 v176, v174
    v_cvt_pk_bf16_f32 v150, v96, v97
    v_permlane32_swap_b32 v240, v172
    v_permlane32_swap_b32 v174, v176
    v_pk_fma_f32 v[52:53], v[52:53], s[70:71], v[240:241] op_sel_hi:[1,1,0] neg_lo:[0,0,1] neg_hi:[0,0,1]
    v_pk_fma_f32 v[54:55], v[54:55], s[70:71], v[240:241] op_sel_hi:[1,1,0] neg_lo:[0,0,1] neg_hi:[0,0,1]
    v_pk_fma_f32 v[56:57], v[56:57], s[70:71], v[172:173] op_sel_hi:[1,1,0] neg_lo:[0,0,1] neg_hi:[0,0,1]
    v_pk_fma_f32 v[58:59], v[58:59], s[70:71], v[172:173] op_sel_hi:[1,1,0] neg_lo:[0,0,1] neg_hi:[0,0,1]
    v_exp_f32 v52, v52
    v_exp_f32 v53, v53
    v_exp_f32 v54, v54
    v_exp_f32 v55, v55
    v_exp_f32 v56, v56
    v_exp_f32 v57, v57
    v_exp_f32 v58, v58
    v_exp_f32 v59, v59
    v_pk_fma_f32 v[60:61], v[60:61], s[70:71], v[174:175] op_sel_hi:[1,1,0] neg_lo:[0,0,1] neg_hi:[0,0,1]
    v_pk_fma_f32 v[62:63], v[62:63], s[70:71], v[174:175] op_sel_hi:[1,1,0] neg_lo:[0,0,1] neg_hi:[0,0,1]
    v_pk_fma_f32 v[64:65], v[64:65], s[70:71], v[176:177] op_sel_hi:[1,1,0] neg_lo:[0,0,1] neg_hi:[0,0,1]
    v_pk_fma_f32 v[66:67], v[66:67], s[70:71], v[176:177] op_sel_hi:[1,1,0] neg_lo:[0,0,1] neg_hi:[0,0,1]
    v_exp_f32 v60, v60
    v_exp_f32 v61, v61
    v_exp_f32 v62, v62
    v_exp_f32 v63, v63
    v_exp_f32 v64, v64
    v_exp_f32 v65, v65
    v_exp_f32 v66, v66
    v_exp_f32 v67, v67
    v_cvt_pk_bf16_f32 v12, v52, v53
    v_cvt_pk_bf16_f32 v13, v54, v55
    v_cvt_pk_bf16_f32 v14, v56, v57
    v_cvt_pk_bf16_f32 v15, v58, v59
    v_mfma_f32_16x16x16_bf16 v[120:123], v[30:31], v[12:13], 0
    v_cvt_pk_bf16_f32 v254, v60, v61
    v_cvt_pk_bf16_f32 v255, v62, v63
    v_mfma_f32_16x16x16_bf16 v[124:127], v[30:31], v[14:15], 0
    v_cvt_pk_bf16_f32 v154, v64, v65
    v_cvt_pk_bf16_f32 v155, v66, v67
    v_mfma_f32_16x16x16_bf16 v[128:131], v[30:31], v[254:255], 0
    v_cvt_pk_bf16_f32 v151, v98, v99
    v_cvt_pk_bf16_f32 v152, v100, v101
    v_mfma_f32_16x16x16_bf16 v[132:135], v[30:31], v[154:155], 0
    v_cvt_pk_bf16_f32 v153, v102, v103
    v_and_b32 v88, v28, v12
    v_and_b32 v89, v29, v13
    v_and_b32 v90, v8, v12
    v_and_b32 v91, v9, v13
    v_and_b32 v92, v28, v14
    v_and_b32 v93, v29, v15
    v_mfma_f32_16x16x32_bf16 v[52:55], v[144:147], v[88:91], 0
    v_and_b32 v94, v8, v14
    v_and_b32 v95, v9, v15
    v_and_b32 v96, v28, v254
    v_and_b32 v97, v29, v255
    v_mfma_f32_16x16x32_bf16 v[56:59], v[146:149], v[92:95], 0
    v_and_b32 v98, v8, v254
    v_and_b32 v99, v9, v255
    v_and_b32 v100, v28, v154
    v_and_b32 v101, v29, v155
    v_mfma_f32_16x16x32_bf16 v[60:63], v[148:151], v[96:99], 0
    v_and_b32 v102, v8, v154
    v_and_b32 v103, v9, v155
    v_rcp_f32 v120, v120
    v_rcp_f32 v124, v124
    v_mfma_f32_16x16x32_bf16 v[64:67], v[150:153], v[100:103], 0
    v_rcp_f32 v128, v128
    v_rcp_f32 v132, v132
    v_pk_mul_f32 v[52:53], v[52:53], v[120:121] op_sel_hi:[1,0]
    v_pk_mul_f32 v[54:55], v[54:55], v[120:121] op_sel_hi:[1,0]
    v_pk_mul_f32 v[56:57], v[56:57], v[124:125] op_sel_hi:[1,0]
    v_pk_mul_f32 v[58:59], v[58:59], v[124:125] op_sel_hi:[1,0]
    v_cvt_pk_bf16_f32 v68, v52, v53
    v_cvt_pk_bf16_f32 v69, v54, v55
    v_cvt_pk_bf16_f32 v70, v56, v57
    v_cvt_pk_bf16_f32 v71, v58, v59
    v_pk_mul_f32 v[60:61], v[60:61], v[128:129] op_sel_hi:[1,0]
    v_pk_mul_f32 v[62:63], v[62:63], v[128:129] op_sel_hi:[1,0]
    v_pk_mul_f32 v[64:65], v[64:65], v[132:133] op_sel_hi:[1,0]
    v_pk_mul_f32 v[66:67], v[66:67], v[132:133] op_sel_hi:[1,0]
    v_cvt_pk_bf16_f32 v200, v60, v61
    v_cvt_pk_bf16_f32 v201, v62, v63
    v_cvt_pk_bf16_f32 v202, v64, v65
    v_cvt_pk_bf16_f32 v203, v66, v67
    v_permlane16_swap_b32 v68, v70
    v_permlane16_swap_b32 v69, v71
    v_permlane16_swap_b32 v200, v202
    v_permlane16_swap_b32 v201, v203
    buffer_store_dwordx4 v[68:71], v7, s[12:15], s46 offen sc1
    buffer_store_dwordx4 v[200:203], v7, s[12:15], s47 offen sc1
    s_barrier
L_p2pre:
    v_xor_b32 v2, 32, v1
    v_xor_b32 v3, 64, v1
    v_xor_b32 v4, 96, v1
    ds_read_b64_tr_b16 v[64:65], v1 offset:0
    ds_read_b64_tr_b16 v[66:67], v1 offset:512
    ds_read_b64_tr_b16 v[68:69], v2 offset:0
    ds_read_b64_tr_b16 v[70:71], v2 offset:512
    ds_read_b64_tr_b16 v[72:73], v3 offset:0
    ds_read_b64_tr_b16 v[74:75], v3 offset:512
    ds_read_b64_tr_b16 v[76:77], v4 offset:0
    ds_read_b64_tr_b16 v[78:79], v4 offset:512
    v_lshl_add_u32 v6, v0, 4, s59
    s_cmp_eq_u32 s57, 0
    s_waitcnt lgkmcnt(7)
    ds_read_b64_tr_b16 v[80:81], v1 offset:4096
    ds_read_b64_tr_b16 v[82:83], v1 offset:4608
    ds_read_b64_tr_b16 v[84:85], v2 offset:4096
    ds_read_b64_tr_b16 v[86:87], v2 offset:4608
    ds_read_b64_tr_b16 v[88:89], v3 offset:4096
    ds_read_b64_tr_b16 v[90:91], v3 offset:4608
    ds_read_b64_tr_b16 v[92:93], v4 offset:4096
    ds_read_b64_tr_b16 v[94:95], v4 offset:4608
    s_waitcnt lgkmcnt(7)
    ds_read_b64_tr_b16 v[96:97], v1 offset:8192
    ds_read_b64_tr_b16 v[98:99], v1 offset:8704
    ds_read_b64_tr_b16 v[100:101], v2 offset:8192
    ds_read_b64_tr_b16 v[102:103], v2 offset:8704
    ds_read_b64_tr_b16 v[104:105], v3 offset:8192
    ds_read_b64_tr_b16 v[106:107], v3 offset:8704
    ds_read_b64_tr_b16 v[108:109], v4 offset:8192
    ds_read_b64_tr_b16 v[110:111], v4 offset:8704
    s_waitcnt lgkmcnt(7)
    ds_read_b64_tr_b16 v[112:113], v1 offset:12288
    ds_read_b64_tr_b16 v[114:115], v1 offset:12800
    ds_read_b64_tr_b16 v[116:117], v2 offset:12288
    ds_read_b64_tr_b16 v[118:119], v2 offset:12800
    ds_read_b64_tr_b16 v[120:121], v3 offset:12288
    ds_read_b64_tr_b16 v[122:123], v3 offset:12800
    ds_read_b64_tr_b16 v[124:125], v4 offset:12288
    ds_read_b64_tr_b16 v[126:127], v4 offset:12800
    s_waitcnt lgkmcnt(7)
    ds_read_b64_tr_b16 v[128:129], v1 offset:16384
    ds_read_b64_tr_b16 v[130:131], v1 offset:16896
    ds_read_b64_tr_b16 v[132:133], v2 offset:16384
    ds_read_b64_tr_b16 v[134:135], v2 offset:16896
    ds_read_b64_tr_b16 v[136:137], v3 offset:16384
    ds_read_b64_tr_b16 v[138:139], v3 offset:16896
    ds_read_b64_tr_b16 v[140:141], v4 offset:16384
    ds_read_b64_tr_b16 v[142:143], v4 offset:16896
    s_waitcnt lgkmcnt(7)
    ds_read_b64_tr_b16 v[144:145], v1 offset:20480
    ds_read_b64_tr_b16 v[146:147], v1 offset:20992
    ds_read_b64_tr_b16 v[148:149], v2 offset:20480
    ds_read_b64_tr_b16 v[150:151], v2 offset:20992
    ds_read_b64_tr_b16 v[152:153], v3 offset:20480
    ds_read_b64_tr_b16 v[154:155], v3 offset:20992
    ds_read_b64_tr_b16 v[156:157], v4 offset:20480
    ds_read_b64_tr_b16 v[158:159], v4 offset:20992
    s_waitcnt lgkmcnt(7)
    ds_read_b64_tr_b16 v[160:161], v1 offset:24576
    ds_read_b64_tr_b16 v[162:163], v1 offset:25088
    ds_read_b64_tr_b16 v[164:165], v2 offset:24576
    ds_read_b64_tr_b16 v[166:167], v2 offset:25088
    ds_read_b64_tr_b16 v[168:169], v3 offset:24576
    ds_read_b64_tr_b16 v[170:171], v3 offset:25088
    ds_read_b64_tr_b16 v[172:173], v4 offset:24576
    ds_read_b64_tr_b16 v[174:175], v4 offset:25088
    s_waitcnt lgkmcnt(7)
    ds_read_b64_tr_b16 v[176:177], v1 offset:28672
    ds_read_b64_tr_b16 v[178:179], v1 offset:29184
    ds_read_b64_tr_b16 v[180:181], v2 offset:28672
    ds_read_b64_tr_b16 v[182:183], v2 offset:29184
    ds_read_b64_tr_b16 v[184:185], v3 offset:28672
    ds_read_b64_tr_b16 v[186:187], v3 offset:29184
    ds_read_b64_tr_b16 v[188:189], v4 offset:28672
    ds_read_b64_tr_b16 v[190:191], v4 offset:29184
    s_waitcnt lgkmcnt(7)
    ds_read_b64_tr_b16 v[192:193], v1 offset:32768
    ds_read_b64_tr_b16 v[194:195], v1 offset:33280
    ds_read_b64_tr_b16 v[196:197], v2 offset:32768
    ds_read_b64_tr_b16 v[198:199], v2 offset:33280
    ds_read_b64_tr_b16 v[200:201], v3 offset:32768
    ds_read_b64_tr_b16 v[202:203], v3 offset:33280
    ds_read_b64_tr_b16 v[204:205], v4 offset:32768
    ds_read_b64_tr_b16 v[206:207], v4 offset:33280
    s_waitcnt lgkmcnt(7)
    ds_read_b64_tr_b16 v[208:209], v1 offset:36864
    ds_read_b64_tr_b16 v[210:211], v1 offset:37376
    ds_read_b64_tr_b16 v[212:213], v2 offset:36864
    ds_read_b64_tr_b16 v[214:215], v2 offset:37376
    ds_read_b64_tr_b16 v[216:217], v3 offset:36864
    ds_read_b64_tr_b16 v[218:219], v3 offset:37376
    ds_read_b64_tr_b16 v[220:221], v4 offset:36864
    ds_read_b64_tr_b16 v[222:223], v4 offset:37376
    s_waitcnt lgkmcnt(7)
    ds_read_b64_tr_b16 v[224:225], v1 offset:40960
    ds_read_b64_tr_b16 v[226:227], v1 offset:41472
    ds_read_b64_tr_b16 v[228:229], v2 offset:40960
    ds_read_b64_tr_b16 v[230:231], v2 offset:41472
    ds_read_b64_tr_b16 v[232:233], v3 offset:40960
    ds_read_b64_tr_b16 v[234:235], v3 offset:41472
    ds_read_b64_tr_b16 v[236:237], v4 offset:40960
    ds_read_b64_tr_b16 v[238:239], v4 offset:41472
    s_cbranch_scc1 L_p2b
    s_waitcnt vmcnt(1)
    s_setprio 0
    s_barrier
    v_dot2_f32_bf16 v28, v16, v24, 0
    v_dot2_f32_bf16 v29, v20, v24, 0
    v_dot2_f32_bf16 v28, v17, v25, v28
    v_dot2_f32_bf16 v29, v21, v25, v29
    v_dot2_f32_bf16 v28, v18, v26, v28
    v_dot2_f32_bf16 v29, v22, v26, v29
    v_dot2_f32_bf16 v28, v19, v27, v28
    v_dot2_f32_bf16 v29, v23, v27, v29
    s_nop 2
    v_permlane32_swap_b32 v28, v29
    v_add_f32 v28, v28, v29
    s_nop 1
    v_add_f32_dpp v28, v28, v28 row_ror:8 row_mask:0xf bank_mask:0xf
    s_nop 1
    v_add_f32_dpp v28, v28, v28 row_ror:4 row_mask:0xf bank_mask:0xf
    s_nop 1
    v_add_f32_dpp v28, v28, v28 row_ror:2 row_mask:0xf bank_mask:0xf
    s_nop 1
    v_add_f32_dpp v28, v28, v28 row_ror:1 row_mask:0xf bank_mask:0xf
    v_mov_b32 v29, v28
    s_nop 1
    v_permlane16_swap_b32 v28, v29
    v_add_f32 v28, v28, v29
    v_mul_f32 v28, 0xbfb8aa3b, v28
    v_exp_f32 v28, v28
    s_nop 0
    v_add_f32 v28, 1.0, v28
    v_rcp_f32 v15, v28
    s_mov_b32 exec_lo, 1
    s_mov_b32 exec_hi, 1
    buffer_store_dword v15, v8, s[12:15], 0 offen sc1
    s_mov_b64 exec, -1
L_p2b:
    s_waitcnt lgkmcnt(7)
    ds_read_b64_tr_b16 v[240:241], v1 offset:45056
    ds_read_b64_tr_b16 v[242:243], v1 offset:45568
    ds_read_b64_tr_b16 v[244:245], v2 offset:45056
    ds_read_b64_tr_b16 v[246:247], v2 offset:45568
    ds_read_b64_tr_b16 v[248:249], v3 offset:45056
    ds_read_b64_tr_b16 v[250:251], v3 offset:45568
    ds_read_b64_tr_b16 v[252:253], v4 offset:45056
    ds_read_b64_tr_b16 v[254:255], v4 offset:45568
    s_cmp_lg_u32 s3, 4
    s_cbranch_scc1 L_go
L_probe:
    buffer_load_dword v15, v5, s[12:15], 0 offen sc1
    buffer_load_dword v12, v7, s[12:15], 0 offen sc1
    s_sub_i32 s56, s56, 1
    s_cmp_lt_i32 s56, 0
    s_waitcnt vmcnt(0)
    s_cbranch_scc1 L_probe_x
    v_cmp_ne_u32 s[54:55], 0, v15
    v_cmp_ne_u32 vcc, -1, v12
    s_nop 0
    s_and_b64 vcc, vcc, s[54:55]
    s_cmp_eq_u64 vcc, -1
    s_cbranch_scc0 L_probe
L_probe_x:
L_go:
    s_barrier
L_go2:
    buffer_load_dwordx4 v[32:35], v6, s[12:15], s72 offen offset:0 sc1
    buffer_load_dwordx4 v[36:39], v6, s[12:15], s72 offen offset:1024 sc1
    buffer_load_dwordx4 v[40:43], v6, s[12:15], s73 offen offset:0 sc1
    buffer_load_dwordx4 v[44:47], v6, s[12:15], s73 offen offset:1024 sc1
    s_cmp_eq_u32 s57, 0
    s_cselect_b64 vcc, -1, 0
    v_mov_b32 v15, 0
    s_cselect_b64 s[54:55], -1, 0
    s_mov_b32 s44, 81920
    v_lshl_add_u32 v12, v0, 2, s44
    v_and_b32 v9, 15, v0
    s_lshl_b32 s45, s43, 6
    s_add_u32 s44, s44, s45
    v_lshl_add_u32 v9, v9, 2, s44
    s_cmp_lg_u32 s3, 0
    v_lshl_add_u32 v13, v0, 4, s64
    v_xor_b32 v14, 0x2000, v13
    s_waitcnt lgkmcnt(0)
    s_waitcnt vmcnt(3)
    v_mfma_f32_16x16x32_bf16 v[16:19], v[64:67], v[32:35], 0
    buffer_load_dwordx4 v[48:51], v6, s[12:15], s74 offen offset:0 sc1
    v_max3_u32 v15, v15, v32, v33
    v_mfma_f32_16x16x32_bf16 v[20:23], v[68:71], v[32:35], 0
    v_max3_u32 v15, v15, v34, v35
    v_mfma_f32_16x16x32_bf16 v[24:27], v[72:75], v[32:35], 0
    v_mfma_f32_16x16x32_bf16 v[28:31], v[76:79], v[32:35], 0
    s_waitcnt vmcnt(3)
    v_mfma_f32_16x16x32_bf16 v[16:19], v[80:83], v[36:39], v[16:19]
    buffer_load_dwordx4 v[32:35], v6, s[12:15], s74 offen offset:1024 sc1
    v_max3_u32 v15, v15, v36, v37
    v_mfma_f32_16x16x32_bf16 v[20:23], v[84:87], v[36:39], v[20:23]
    v_max3_u32 v15, v15, v38, v39
    v_mfma_f32_16x16x32_bf16 v[24:27], v[88:91], v[36:39], v[24:27]
    ds_read_b64_tr_b16 v[64:65], v1 offset:49152
    ds_read_b64_tr_b16 v[66:67], v1 offset:49664
    v_mfma_f32_16x16x32_bf16 v[28:31], v[92:95], v[36:39], v[28:31]
    ds_read_b64_tr_b16 v[68:69], v2 offset:49152
    ds_read_b64_tr_b16 v[70:71], v2 offset:49664
    s_waitcnt vmcnt(3)
    v_mfma_f32_16x16x32_bf16 v[16:19], v[96:99], v[40:43], v[16:19]
    buffer_load_dwordx4 v[36:39], v6, s[12:15], s75 offen offset:0 sc1
    v_max3_u32 v15, v15, v40, v41
    v_mfma_f32_16x16x32_bf16 v[20:23], v[100:103], v[40:43], v[20:23]
    v_max3_u32 v15, v15, v42, v43
    v_mfma_f32_16x16x32_bf16 v[24:27], v[104:107], v[40:43], v[24:27]
    ds_read_b64_tr_b16 v[72:73], v3 offset:49152
    ds_read_b64_tr_b16 v[74:75], v3 offset:49664
    v_mfma_f32_16x16x32_bf16 v[28:31], v[108:111], v[40:43], v[28:31]
    ds_read_b64_tr_b16 v[76:77], v4 offset:49152
    ds_read_b64_tr_b16 v[78:79], v4 offset:49664
    s_waitcnt vmcnt(3)
    v_mfma_f32_16x16x32_bf16 v[16:19], v[112:115], v[44:47], v[16:19]
    buffer_load_dwordx4 v[40:43], v6, s[12:15], s75 offen offset:1024 sc1
    v_max3_u32 v15, v15, v44, v45
    v_mfma_f32_16x16x32_bf16 v[20:23], v[116:119], v[44:47], v[20:23]
    v_max3_u32 v15, v15, v46, v47
    v_mfma_f32_16x16x32_bf16 v[24:27], v[120:123], v[44:47], v[24:27]
    ds_read_b64_tr_b16 v[80:81], v1 offset:53248
    ds_read_b64_tr_b16 v[82:83], v1 offset:53760
    v_mfma_f32_16x16x32_bf16 v[28:31], v[124:127], v[44:47], v[28:31]
    ds_read_b64_tr_b16 v[84:85], v2 offset:53248
    ds_read_b64_tr_b16 v[86:87], v2 offset:53760
    s_waitcnt vmcnt(3)
    v_mfma_f32_16x16x32_bf16 v[16:19], v[128:131], v[48:51], v[16:19]
    buffer_load_dwordx4 v[44:47], v6, s[12:15], s76 offen offset:0 sc1
    v_max3_u32 v15, v15, v48, v49
    v_mfma_f32_16x16x32_bf16 v[20:23], v[132:135], v[48:51], v[20:23]
    v_max3_u32 v15, v15, v50, v51
    v_mfma_f32_16x16x32_bf16 v[24:27], v[136:139], v[48:51], v[24:27]
    ds_read_b64_tr_b16 v[88:89], v3 offset:53248
    ds_read_b64_tr_b16 v[90:91], v3 offset:53760
    v_mfma_f32_16x16x32_bf16 v[28:31], v[140:143], v[48:51], v[28:31]
    ds_read_b64_tr_b16 v[92:93], v4 offset:53248
    ds_read_b64_tr_b16 v[94:95], v4 offset:53760
    s_waitcnt vmcnt(3)
    v_mfma_f32_16x16x32_bf16 v[16:19], v[144:147], v[32:35], v[16:19]
    buffer_load_dwordx4 v[48:51], v6, s[12:15], s76 offen offset:1024 sc1
    v_max3_u32 v15, v15, v32, v33
    v_mfma_f32_16x16x32_bf16 v[20:23], v[148:151], v[32:35], v[20:23]
    v_max3_u32 v15, v15, v34, v35
    v_mfma_f32_16x16x32_bf16 v[24:27], v[152:155], v[32:35], v[24:27]
    ds_read_b64_tr_b16 v[96:97], v1 offset:57344
    ds_read_b64_tr_b16 v[98:99], v1 offset:57856
    v_mfma_f32_16x16x32_bf16 v[28:31], v[156:159], v[32:35], v[28:31]
    ds_read_b64_tr_b16 v[100:101], v2 offset:57344
    ds_read_b64_tr_b16 v[102:103], v2 offset:57856
    s_waitcnt vmcnt(3)
    v_mfma_f32_16x16x32_bf16 v[16:19], v[160:163], v[36:39], v[16:19]
    buffer_load_dwordx4 v[32:35], v6, s[12:15], s77 offen offset:0 sc1
    v_max3_u32 v15, v15, v36, v37
    v_mfma_f32_16x16x32_bf16 v[20:23], v[164:167], v[36:39], v[20:23]
    v_max3_u32 v15, v15, v38, v39
    v_mfma_f32_16x16x32_bf16 v[24:27], v[168:171], v[36:39], v[24:27]
    ds_read_b64_tr_b16 v[104:105], v3 offset:57344
    ds_read_b64_tr_b16 v[106:107], v3 offset:57856
    v_mfma_f32_16x16x32_bf16 v[28:31], v[172:175], v[36:39], v[28:31]
    ds_read_b64_tr_b16 v[108:109], v4 offset:57344
    ds_read_b64_tr_b16 v[110:111], v4 offset:57856
    s_waitcnt vmcnt(3)
    v_mfma_f32_16x16x32_bf16 v[16:19], v[176:179], v[40:43], v[16:19]
    buffer_load_dwordx4 v[36:39], v6, s[12:15], s77 offen offset:1024 sc1
    v_max3_u32 v15, v15, v40, v41
    v_mfma_f32_16x16x32_bf16 v[20:23], v[180:183], v[40:43], v[20:23]
    v_max3_u32 v15, v15, v42, v43
    v_mfma_f32_16x16x32_bf16 v[24:27], v[184:187], v[40:43], v[24:27]
    ds_read_b64_tr_b16 v[112:113], v1 offset:61440
    ds_read_b64_tr_b16 v[114:115], v1 offset:61952
    v_mfma_f32_16x16x32_bf16 v[28:31], v[188:191], v[40:43], v[28:31]
    ds_read_b64_tr_b16 v[116:117], v2 offset:61440
    ds_read_b64_tr_b16 v[118:119], v2 offset:61952
    s_waitcnt vmcnt(3)
    v_mfma_f32_16x16x32_bf16 v[16:19], v[192:195], v[44:47], v[16:19]
    buffer_load_dwordx4 v[40:43], v6, s[12:15], s78 offen offset:0 sc1
    v_max3_u32 v15, v15, v44, v45
    v_mfma_f32_16x16x32_bf16 v[20:23], v[196:199], v[44:47], v[20:23]
    s_cbranch_scc1 L_nog0
    buffer_load_dword v8, v11, s[12:15], 0 offen sc1
L_nog0:
    v_max3_u32 v15, v15, v46, v47
    v_mfma_f32_16x16x32_bf16 v[24:27], v[200:203], v[44:47], v[24:27]
    ds_read_b64_tr_b16 v[120:121], v3 offset:61440
    ds_read_b64_tr_b16 v[122:123], v3 offset:61952
    v_mfma_f32_16x16x32_bf16 v[28:31], v[204:207], v[44:47], v[28:31]
    ds_read_b64_tr_b16 v[124:125], v4 offset:61440
    ds_read_b64_tr_b16 v[126:127], v4 offset:61952
    s_waitcnt vmcnt(3)
    v_mfma_f32_16x16x32_bf16 v[16:19], v[208:211], v[48:51], v[16:19]
    buffer_load_dwordx4 v[44:47], v6, s[12:15], s78 offen offset:1024 sc1
    v_max3_u32 v15, v15, v48, v49
    v_mfma_f32_16x16x32_bf16 v[20:23], v[212:215], v[48:51], v[20:23]
    v_max3_u32 v15, v15, v50, v51
    v_mfma_f32_16x16x32_bf16 v[24:27], v[216:219], v[48:51], v[24:27]
    v_mfma_f32_16x16x32_bf16 v[28:31], v[220:223], v[48:51], v[28:31]
    s_waitcnt vmcnt(3)
    v_mfma_f32_16x16x32_bf16 v[16:19], v[224:227], v[32:35], v[16:19]
    buffer_load_dwordx4 v[48:51], v6, s[12:15], s79 offen offset:0 sc1
    v_max3_u32 v15, v15, v32, v33
    v_mfma_f32_16x16x32_bf16 v[20:23], v[228:231], v[32:35], v[20:23]
    v_max3_u32 v15, v15, v34, v35
    v_mfma_f32_16x16x32_bf16 v[24:27], v[232:235], v[32:35], v[24:27]
    v_mfma_f32_16x16x32_bf16 v[28:31], v[236:239], v[32:35], v[28:31]
    s_waitcnt vmcnt(3)
    v_mfma_f32_16x16x32_bf16 v[16:19], v[240:243], v[36:39], v[16:19]
    buffer_load_dwordx4 v[32:35], v6, s[12:15], s79 offen offset:1024 sc1
    v_max3_u32 v15, v15, v36, v37
    v_mfma_f32_16x16x32_bf16 v[20:23], v[244:247], v[36:39], v[20:23]
    v_max3_u32 v15, v15, v38, v39
    v_mfma_f32_16x16x32_bf16 v[24:27], v[248:251], v[36:39], v[24:27]
    v_mfma_f32_16x16x32_bf16 v[28:31], v[252:255], v[36:39], v[28:31]
    s_waitcnt vmcnt(3) lgkmcnt(0)
    v_mfma_f32_16x16x32_bf16 v[16:19], v[64:67], v[40:43], v[16:19]
    v_max3_u32 v15, v15, v40, v41
    v_mfma_f32_16x16x32_bf16 v[20:23], v[68:71], v[40:43], v[20:23]
    v_max3_u32 v15, v15, v42, v43
    v_mfma_f32_16x16x32_bf16 v[24:27], v[72:75], v[40:43], v[24:27]
    v_mfma_f32_16x16x32_bf16 v[28:31], v[76:79], v[40:43], v[28:31]
    s_waitcnt vmcnt(2)
    v_mfma_f32_16x16x32_bf16 v[16:19], v[80:83], v[44:47], v[16:19]
    v_max3_u32 v15, v15, v44, v45
    v_mfma_f32_16x16x32_bf16 v[20:23], v[84:87], v[44:47], v[20:23]
    v_max3_u32 v15, v15, v46, v47
    v_mfma_f32_16x16x32_bf16 v[24:27], v[88:91], v[44:47], v[24:27]
    s_cbranch_scc1 L_nog1
    v_max_u32 v15, v15, v8
    ds_write_b32 v12, v8
L_nog1:
    v_mfma_f32_16x16x32_bf16 v[28:31], v[92:95], v[44:47], v[28:31]
    s_waitcnt vmcnt(1)
    v_mfma_f32_16x16x32_bf16 v[16:19], v[96:99], v[48:51], v[16:19]
    v_max3_u32 v15, v15, v48, v49
    v_mfma_f32_16x16x32_bf16 v[20:23], v[100:103], v[48:51], v[20:23]
    v_max3_u32 v15, v15, v50, v51
    v_mfma_f32_16x16x32_bf16 v[24:27], v[104:107], v[48:51], v[24:27]
    v_mfma_f32_16x16x32_bf16 v[28:31], v[108:111], v[48:51], v[28:31]
    s_waitcnt vmcnt(0)
    v_mfma_f32_16x16x32_bf16 v[24:27], v[120:123], v[32:35], v[24:27]
    v_max3_u32 v15, v15, v32, v33
    v_mfma_f32_16x16x32_bf16 v[28:31], v[124:127], v[32:35], v[28:31]
    v_max3_u32 v15, v15, v34, v35
    v_mfma_f32_16x16x32_bf16 v[16:19], v[112:115], v[32:35], v[16:19]
    v_cmp_eq_u32 vcc, -1, v15
    v_mfma_f32_16x16x32_bf16 v[20:23], v[116:119], v[32:35], v[20:23]
    s_cbranch_vccnz L_redo
L_fin:
    s_nop 0
    ds_write_b128 v13, v[24:27]
    s_nop 0
    ds_write_b128 v13, v[28:31] offset:1024
    s_waitcnt lgkmcnt(0)
    s_barrier
    ds_read_b32 v8, v9
    ds_read_b128 v[32:35], v14
    ds_read_b128 v[36:39], v14 offset:1024
    s_waitcnt lgkmcnt(1)
    v_sub_f32 v12, 1.0, v8
    v_pk_add_f32 v[16:17], v[16:17], v[32:33] neg_lo:[0,1] neg_hi:[0,1]
    v_pk_add_f32 v[18:19], v[18:19], v[34:35] neg_lo:[0,1] neg_hi:[0,1]
    v_cndmask_b32 v8, v12, v8, s[54:55]
    s_waitcnt lgkmcnt(0)
    v_pk_add_f32 v[20:21], v[20:21], v[36:37] neg_lo:[0,1] neg_hi:[0,1]
    v_pk_add_f32 v[22:23], v[22:23], v[38:39] neg_lo:[0,1] neg_hi:[0,1]
    v_pk_fma_f32 v[16:17], v[16:17], v[8:9], v[32:33] op_sel_hi:[1,0,1]
    v_pk_fma_f32 v[18:19], v[18:19], v[8:9], v[34:35] op_sel_hi:[1,0,1]
    v_pk_fma_f32 v[20:21], v[20:21], v[8:9], v[36:37] op_sel_hi:[1,0,1]
    v_pk_fma_f32 v[22:23], v[22:23], v[8:9], v[38:39] op_sel_hi:[1,0,1]
    v_cvt_pk_bf16_f32 v40, v16, v17
    v_cvt_pk_bf16_f32 v41, v18, v19
    v_cvt_pk_bf16_f32 v42, v20, v21
    v_cvt_pk_bf16_f32 v43, v22, v23
    s_nop 0
    v_permlane16_swap_b32 v40, v42
    v_permlane16_swap_b32 v41, v43
    buffer_store_dwordx4 v[40:43], v10, s[24:27], 0 offen sc1
L_end:
    s_endpgm
L_redo:
    s_sub_i32 s56, s56, 256
    s_cmp_lt_i32 s56, 0
    s_nop 7
    s_cbranch_scc1 L_fin
    ds_read_b64_tr_b16 v[64:65], v1 offset:0
    ds_read_b64_tr_b16 v[66:67], v1 offset:512
    ds_read_b64_tr_b16 v[68:69], v2 offset:0
    ds_read_b64_tr_b16 v[70:71], v2 offset:512
    ds_read_b64_tr_b16 v[72:73], v3 offset:0
    ds_read_b64_tr_b16 v[74:75], v3 offset:512
    ds_read_b64_tr_b16 v[76:77], v4 offset:0
    ds_read_b64_tr_b16 v[78:79], v4 offset:512
    s_waitcnt lgkmcnt(7)
    ds_read_b64_tr_b16 v[80:81], v1 offset:4096
    ds_read_b64_tr_b16 v[82:83], v1 offset:4608
    ds_read_b64_tr_b16 v[84:85], v2 offset:4096
    ds_read_b64_tr_b16 v[86:87], v2 offset:4608
    ds_read_b64_tr_b16 v[88:89], v3 offset:4096
    ds_read_b64_tr_b16 v[90:91], v3 offset:4608
    ds_read_b64_tr_b16 v[92:93], v4 offset:4096
    ds_read_b64_tr_b16 v[94:95], v4 offset:4608
    s_waitcnt lgkmcnt(7)
    ds_read_b64_tr_b16 v[96:97], v1 offset:8192
    ds_read_b64_tr_b16 v[98:99], v1 offset:8704
    ds_read_b64_tr_b16 v[100:101], v2 offset:8192
    ds_read_b64_tr_b16 v[102:103], v2 offset:8704
    ds_read_b64_tr_b16 v[104:105], v3 offset:8192
    ds_read_b64_tr_b16 v[106:107], v3 offset:8704
    ds_read_b64_tr_b16 v[108:109], v4 offset:8192
    ds_read_b64_tr_b16 v[110:111], v4 offset:8704
    s_waitcnt lgkmcnt(7)
    ds_read_b64_tr_b16 v[112:113], v1 offset:12288
    ds_read_b64_tr_b16 v[114:115], v1 offset:12800
    ds_read_b64_tr_b16 v[116:117], v2 offset:12288
    ds_read_b64_tr_b16 v[118:119], v2 offset:12800
    ds_read_b64_tr_b16 v[120:121], v3 offset:12288
    ds_read_b64_tr_b16 v[122:123], v3 offset:12800
    ds_read_b64_tr_b16 v[124:125], v4 offset:12288
    ds_read_b64_tr_b16 v[126:127], v4 offset:12800
    s_branch L_go2
L_rst:
    buffer_load_dword v12, v9, s[28:31], 0 offen offset:64 sc1
    s_sub_i32 s56, s56, 1
    s_cmp_lt_i32 s56, 0
    s_waitcnt vmcnt(0)
    s_cbranch_scc1 L_rst_x
    v_cmp_ne_u32 vcc, 0, v12
    s_nop 0
    s_cmp_eq_u64 vcc, -1
    s_cbranch_scc0 L_rst
L_rst_x:
    s_branch L_rst_ok
.section .rodata,"a"
.p2align 6
.amdhsa_kernel gated_mix__sliding_local_dilated__sliding_local_dilated__prompt_kernel
  .amdhsa_next_free_vgpr 256
  .amdhsa_next_free_sgpr 102
  .amdhsa_accum_offset 256
  .amdhsa_group_segment_fixed_size 0
  .amdhsa_kernarg_size 80
  .amdhsa_user_sgpr_count 2
  .amdhsa_user_sgpr_kernarg_segment_ptr 1
  .amdhsa_system_sgpr_workgroup_id_x 1
.end_amdhsa_kernel
```
